```python
import torch

def _softmax(x, axis=-1):
    return torch.softmax(x, dim=axis)

def _gelu(x):
    return torch.nn.functional.gelu(x, approximate='tanh')

def _silu(x):
    return torch.nn.functional.silu(x)

def _sigmoid(x):
    return torch.sigmoid(x)

def _layernorm(x, axis=-1, eps=1e-05):
    m = x.mean(dim=axis, keepdim=True)
    v = x.var(dim=axis, keepdim=True, unbiased=False)
    return (x - m) / torch.sqrt(v + eps)

def _scatter_add(tgt, idx, src, axis=0):
    return tgt.clone().index_add_(axis, idx, src)

def _segment_sum(src, seg, n):
    out = torch.zeros((n,) + src.shape[1:], dtype=src.dtype)
    return out.index_add_(0, seg, src)

def _pad(x, pw):
    flat = tuple((v for pair in reversed(pw) for v in pair))
    return torch.nn.functional.pad(x, flat)
kernel_name = 'adaLN_cond__mha_block__glu_gated_bilinear__prompt'

def setup_inputs():

    _w = lambda a: (lambda t: t.to(torch.bfloat16) if t.is_floating_point() else t)(torch.as_tensor(a))

    def _A_setup():
        B, S, D, H = (1, 2048, 576, 32)
        return {'x': _w((lambda *s: torch.randn(*s, dtype=torch.bfloat16) * 0.05)(B, S, D)), 'wqkv': _w((lambda *s: torch.randn(*s, dtype=torch.bfloat16) * 0.05)(D, 3 * D)), 'wo': _w((lambda *s: torch.randn(*s, dtype=torch.bfloat16) * 0.05)(D, D))}
    _A_in = _A_setup()

    def _B_setup():
        B, S, D, F = (1, 2048, 576, 4608)
        return {'x': _w((lambda *s: torch.randn(*s, dtype=torch.bfloat16) * 0.05)(B, S, D)), 'w_gate': _w((lambda *s: torch.randn(*s, dtype=torch.bfloat16) * 0.8)(D, F) * D ** (-0.5)), 'w_up': _w((lambda *s: torch.randn(*s, dtype=torch.bfloat16) * 0.8)(D, F) * D ** (-0.5)), 'w_down': _w((lambda *s: torch.randn(*s, dtype=torch.bfloat16) * 0.8)(F, D) * F ** (-0.5))}
    _B_in = _B_setup()
    return {'A_x': _A_in['x'], 'A_wqkv': _A_in['wqkv'], 'A_wo': _A_in['wo'], 'B_x': _B_in['x'], 'B_w_gate': _B_in['w_gate'], 'B_w_up': _B_in['w_up'], 'B_w_down': _B_in['w_down'], 'c': _w((lambda *s: torch.randn(*s, dtype=torch.bfloat16) * 0.2)(1, 576) * 8.0), 'w_mod': _w((lambda *s: torch.randn(*s, dtype=torch.bfloat16) * 0.2)(576, 6 * 576) * 576 ** (-0.5) * 8.0)}

def reference(A_x, A_wqkv, A_wo, B_x, B_w_gate, B_w_up, B_w_down, c, w_mod):

    def _A_ref(x, wqkv, wo):
        B, S, D = x.shape
        H = 32
        Dh = D // H
        qkv = (lambda x, *d: x.permute(*d))((x @ wqkv).reshape(B, S, 3, H, Dh), 2, 0, 3, 1, 4)
        q, k, v = (qkv[0], qkv[1], qkv[2])
        scores = torch.einsum('bhqd,bhkd->bhqk', q, k) * Dh ** (-0.5)
        p = _softmax(scores, axis=-1)
        o = torch.einsum('bhqk,bhkd->bhqd', p, v)
        return (lambda x, *d: x.permute(*d))(o, 0, 2, 1, 3).reshape(B, S, D) @ wo

    def _B_ref(x, w_gate, w_up, w_down):
        g = torch.einsum('bsd,df->bsf', x, w_gate)
        u = torch.einsum('bsd,df->bsf', x, w_up)
        h = g * u
        return torch.einsum('bsf,fd->bsd', h, w_down)
    x = A_x
    mod = (_silu(c) @ w_mod).reshape(c.shape[0], 6, 1, -1)
    sa, ca, ga, sb, cb, gb = (mod[:, 0].clone(), mod[:, 1].clone(), mod[:, 2].clone(), mod[:, 3].clone(), mod[:, 4].clone(), mod[:, 5].clone())
    h = _layernorm(x, axis=-1) * (1 + ca) + sa
    x = x + ga * _A_ref(h, A_wqkv, A_wo)
    h = _layernorm(x, axis=-1) * (1 + cb) + sb
    x = x + gb * _B_ref(h, B_w_gate, B_w_up, B_w_down)
    return x
```

```asm
; @launch kernel=mod_kernel grid=(27,1,1) block=(1024,1,1) lds=16384
; @launch kernel=ln1_kernel grid=(256,1,1) block=(256,1,1) lds=0
; @launch kernel=qkv_kernel grid=(224,1,1) block=(256,1,1) lds=49152
; @launch kernel=attn_kernel grid=(256,1,1) block=(512,1,1) lds=65536
; @launch kernel=wo_kernel grid=(288,1,1) block=(256,1,1) lds=24576
; @launch kernel=ln2_kernel grid=(256,1,1) block=(256,1,1) lds=0
; @launch kernel=gu_kernel grid=(256,1,1) block=(512,1,1) lds=104448
; @launch kernel=down_kernel grid=(288,1,1) block=(256,1,1) lds=32768
.amdgcn_target "amdgcn-amd-amdhsa--gfx950"
.text
.globl mod_kernel
.p2align 8
.type mod_kernel,@function
mod_kernel:
    s_cmp_ge_u32 s2, 27
    s_cbranch_scc1 mod_done
    s_load_dwordx2 s[4:5], s[0:1], 56
    s_load_dwordx2 s[6:7], s[0:1], 64
    s_load_dwordx2 s[8:9], s[0:1], 88
    s_waitcnt lgkmcnt(0)

    s_mov_b32 s12, s4
    s_mov_b32 s13, s5
    s_mov_b32 s14, 1152
    s_mov_b32 s15, 0x00020000
    s_mov_b32 s16, s6
    s_mov_b32 s17, s7
    s_mov_b32 s18, 3981312
    s_mov_b32 s19, 0x00020000
    s_mov_b32 s20, s8
    s_mov_b32 s21, s9
    s_mov_b32 s22, 13824
    s_mov_b32 s23, 0x00020000
    v_lshlrev_b32 v1, 1, v0
    buffer_load_ushort v2, v1, s[12:15], 0 offen
    v_lshlrev_b32 v3, 2, v0
    s_waitcnt vmcnt(0)
    v_lshlrev_b32 v2, 16, v2
    v_mul_f32 v4, 0xbfb8aa3b, v2
    v_exp_f32 v4, v4
    s_nop 0
    v_add_f32 v4, 1.0, v4
    v_rcp_f32 v4, v4
    s_nop 0
    v_mul_f32 v4, v2, v4
    v_cvt_pk_bf16_f32 v4, v4, v4
    v_lshlrev_b32 v4, 16, v4
    v_cmp_gt_u32 vcc, 576, v0
    s_and_saveexec_b64 s[10:11], vcc
    ds_write_b32 v3, v4
    s_mov_b64 exec, s[10:11]
    s_waitcnt lgkmcnt(0)
    s_barrier
    v_lshrrev_b32 v5, 6, v0
    v_and_b32 v6, 63, v0
    s_lshl_b32 s3, s2, 8
    v_mov_b32 v7, 36*6912
    v_mul_lo_u32 v7, v5, v7
    v_lshlrev_b32 v8, 2, v6
    v_add3_u32 v7, v7, v8, s3
    v_mul_u32_u24 v9, 144, v5

    buffer_load_dword v16, v7, s[16:19], 0 offen
    v_add_u32 v7, 6912, v7
    buffer_load_dword v17, v7, s[16:19], 0 offen
    v_add_u32 v7, 6912, v7
    buffer_load_dword v18, v7, s[16:19], 0 offen
    v_add_u32 v7, 6912, v7
    buffer_load_dword v19, v7, s[16:19], 0 offen
    v_add_u32 v7, 6912, v7
    buffer_load_dword v20, v7, s[16:19], 0 offen
    v_add_u32 v7, 6912, v7
    buffer_load_dword v21, v7, s[16:19], 0 offen
    v_add_u32 v7, 6912, v7
    buffer_load_dword v22, v7, s[16:19], 0 offen
    v_add_u32 v7, 6912, v7
    buffer_load_dword v23, v7, s[16:19], 0 offen
    v_add_u32 v7, 6912, v7
    buffer_load_dword v24, v7, s[16:19], 0 offen
    v_add_u32 v7, 6912, v7
    buffer_load_dword v25, v7, s[16:19], 0 offen
    v_add_u32 v7, 6912, v7
    buffer_load_dword v26, v7, s[16:19], 0 offen
    v_add_u32 v7, 6912, v7
    buffer_load_dword v27, v7, s[16:19], 0 offen
    v_add_u32 v7, 6912, v7
    buffer_load_dword v28, v7, s[16:19], 0 offen
    v_add_u32 v7, 6912, v7
    buffer_load_dword v29, v7, s[16:19], 0 offen
    v_add_u32 v7, 6912, v7
    buffer_load_dword v30, v7, s[16:19], 0 offen
    v_add_u32 v7, 6912, v7
    buffer_load_dword v31, v7, s[16:19], 0 offen
    v_add_u32 v7, 6912, v7
    buffer_load_dword v32, v7, s[16:19], 0 offen
    v_add_u32 v7, 6912, v7
    buffer_load_dword v33, v7, s[16:19], 0 offen
    v_add_u32 v7, 6912, v7
    buffer_load_dword v34, v7, s[16:19], 0 offen
    v_add_u32 v7, 6912, v7
    buffer_load_dword v35, v7, s[16:19], 0 offen
    v_add_u32 v7, 6912, v7
    buffer_load_dword v36, v7, s[16:19], 0 offen
    v_add_u32 v7, 6912, v7
    buffer_load_dword v37, v7, s[16:19], 0 offen
    v_add_u32 v7, 6912, v7
    buffer_load_dword v38, v7, s[16:19], 0 offen
    v_add_u32 v7, 6912, v7
    buffer_load_dword v39, v7, s[16:19], 0 offen
    v_add_u32 v7, 6912, v7
    buffer_load_dword v40, v7, s[16:19], 0 offen
    v_add_u32 v7, 6912, v7
    buffer_load_dword v41, v7, s[16:19], 0 offen
    v_add_u32 v7, 6912, v7
    buffer_load_dword v42, v7, s[16:19], 0 offen
    v_add_u32 v7, 6912, v7
    buffer_load_dword v43, v7, s[16:19], 0 offen
    v_add_u32 v7, 6912, v7
    buffer_load_dword v44, v7, s[16:19], 0 offen
    v_add_u32 v7, 6912, v7
    buffer_load_dword v45, v7, s[16:19], 0 offen
    v_add_u32 v7, 6912, v7
    buffer_load_dword v46, v7, s[16:19], 0 offen
    v_add_u32 v7, 6912, v7
    buffer_load_dword v47, v7, s[16:19], 0 offen
    v_add_u32 v7, 6912, v7
    buffer_load_dword v48, v7, s[16:19], 0 offen
    v_add_u32 v7, 6912, v7
    buffer_load_dword v49, v7, s[16:19], 0 offen
    v_add_u32 v7, 6912, v7
    buffer_load_dword v50, v7, s[16:19], 0 offen
    v_add_u32 v7, 6912, v7
    buffer_load_dword v51, v7, s[16:19], 0 offen
    v_add_u32 v7, 6912, v7
    ds_read_b32 v60, v9 offset:0
    ds_read_b32 v61, v9 offset:4
    ds_read_b32 v62, v9 offset:8
    ds_read_b32 v63, v9 offset:12
    ds_read_b32 v64, v9 offset:16
    ds_read_b32 v65, v9 offset:20
    ds_read_b32 v66, v9 offset:24
    ds_read_b32 v67, v9 offset:28
    ds_read_b32 v68, v9 offset:32
    ds_read_b32 v69, v9 offset:36
    ds_read_b32 v70, v9 offset:40
    ds_read_b32 v71, v9 offset:44
    ds_read_b32 v72, v9 offset:48
    ds_read_b32 v73, v9 offset:52
    ds_read_b32 v74, v9 offset:56
    ds_read_b32 v75, v9 offset:60
    ds_read_b32 v76, v9 offset:64
    ds_read_b32 v77, v9 offset:68
    ds_read_b32 v78, v9 offset:72
    ds_read_b32 v79, v9 offset:76
    ds_read_b32 v80, v9 offset:80
    ds_read_b32 v81, v9 offset:84
    ds_read_b32 v82, v9 offset:88
    ds_read_b32 v83, v9 offset:92
    ds_read_b32 v84, v9 offset:96
    ds_read_b32 v85, v9 offset:100
    ds_read_b32 v86, v9 offset:104
    ds_read_b32 v87, v9 offset:108
    ds_read_b32 v88, v9 offset:112
    ds_read_b32 v89, v9 offset:116
    ds_read_b32 v90, v9 offset:120
    ds_read_b32 v91, v9 offset:124
    ds_read_b32 v92, v9 offset:128
    ds_read_b32 v93, v9 offset:132
    ds_read_b32 v94, v9 offset:136
    ds_read_b32 v95, v9 offset:140
    v_mov_b32 v10, 0
    v_mov_b32 v11, 0
    s_waitcnt vmcnt(0) lgkmcnt(0)

    v_lshlrev_b32 v12, 16, v16
    v_and_b32 v13, 0xffff0000, v16
    v_fmac_f32 v10, v12, v60
    v_fmac_f32 v11, v13, v60
    v_lshlrev_b32 v12, 16, v17
    v_and_b32 v13, 0xffff0000, v17
    v_fmac_f32 v10, v12, v61
    v_fmac_f32 v11, v13, v61
    v_lshlrev_b32 v12, 16, v18
    v_and_b32 v13, 0xffff0000, v18
    v_fmac_f32 v10, v12, v62
    v_fmac_f32 v11, v13, v62
    v_lshlrev_b32 v12, 16, v19
    v_and_b32 v13, 0xffff0000, v19
    v_fmac_f32 v10, v12, v63
    v_fmac_f32 v11, v13, v63
    v_lshlrev_b32 v12, 16, v20
    v_and_b32 v13, 0xffff0000, v20
    v_fmac_f32 v10, v12, v64
    v_fmac_f32 v11, v13, v64
    v_lshlrev_b32 v12, 16, v21
    v_and_b32 v13, 0xffff0000, v21
    v_fmac_f32 v10, v12, v65
    v_fmac_f32 v11, v13, v65
    v_lshlrev_b32 v12, 16, v22
    v_and_b32 v13, 0xffff0000, v22
    v_fmac_f32 v10, v12, v66
    v_fmac_f32 v11, v13, v66
    v_lshlrev_b32 v12, 16, v23
    v_and_b32 v13, 0xffff0000, v23
    v_fmac_f32 v10, v12, v67
    v_fmac_f32 v11, v13, v67
    v_lshlrev_b32 v12, 16, v24
    v_and_b32 v13, 0xffff0000, v24
    v_fmac_f32 v10, v12, v68
    v_fmac_f32 v11, v13, v68
    v_lshlrev_b32 v12, 16, v25
    v_and_b32 v13, 0xffff0000, v25
    v_fmac_f32 v10, v12, v69
    v_fmac_f32 v11, v13, v69
    v_lshlrev_b32 v12, 16, v26
    v_and_b32 v13, 0xffff0000, v26
    v_fmac_f32 v10, v12, v70
    v_fmac_f32 v11, v13, v70
    v_lshlrev_b32 v12, 16, v27
    v_and_b32 v13, 0xffff0000, v27
    v_fmac_f32 v10, v12, v71
    v_fmac_f32 v11, v13, v71
    v_lshlrev_b32 v12, 16, v28
    v_and_b32 v13, 0xffff0000, v28
    v_fmac_f32 v10, v12, v72
    v_fmac_f32 v11, v13, v72
    v_lshlrev_b32 v12, 16, v29
    v_and_b32 v13, 0xffff0000, v29
    v_fmac_f32 v10, v12, v73
    v_fmac_f32 v11, v13, v73
    v_lshlrev_b32 v12, 16, v30
    v_and_b32 v13, 0xffff0000, v30
    v_fmac_f32 v10, v12, v74
    v_fmac_f32 v11, v13, v74
    v_lshlrev_b32 v12, 16, v31
    v_and_b32 v13, 0xffff0000, v31
    v_fmac_f32 v10, v12, v75
    v_fmac_f32 v11, v13, v75
    v_lshlrev_b32 v12, 16, v32
    v_and_b32 v13, 0xffff0000, v32
    v_fmac_f32 v10, v12, v76
    v_fmac_f32 v11, v13, v76
    v_lshlrev_b32 v12, 16, v33
    v_and_b32 v13, 0xffff0000, v33
    v_fmac_f32 v10, v12, v77
    v_fmac_f32 v11, v13, v77
    v_lshlrev_b32 v12, 16, v34
    v_and_b32 v13, 0xffff0000, v34
    v_fmac_f32 v10, v12, v78
    v_fmac_f32 v11, v13, v78
    v_lshlrev_b32 v12, 16, v35
    v_and_b32 v13, 0xffff0000, v35
    v_fmac_f32 v10, v12, v79
    v_fmac_f32 v11, v13, v79
    v_lshlrev_b32 v12, 16, v36
    v_and_b32 v13, 0xffff0000, v36
    v_fmac_f32 v10, v12, v80
    v_fmac_f32 v11, v13, v80
    v_lshlrev_b32 v12, 16, v37
    v_and_b32 v13, 0xffff0000, v37
    v_fmac_f32 v10, v12, v81
    v_fmac_f32 v11, v13, v81
    v_lshlrev_b32 v12, 16, v38
    v_and_b32 v13, 0xffff0000, v38
    v_fmac_f32 v10, v12, v82
    v_fmac_f32 v11, v13, v82
    v_lshlrev_b32 v12, 16, v39
    v_and_b32 v13, 0xffff0000, v39
    v_fmac_f32 v10, v12, v83
    v_fmac_f32 v11, v13, v83
    v_lshlrev_b32 v12, 16, v40
    v_and_b32 v13, 0xffff0000, v40
    v_fmac_f32 v10, v12, v84
    v_fmac_f32 v11, v13, v84
    v_lshlrev_b32 v12, 16, v41
    v_and_b32 v13, 0xffff0000, v41
    v_fmac_f32 v10, v12, v85
    v_fmac_f32 v11, v13, v85
    v_lshlrev_b32 v12, 16, v42
    v_and_b32 v13, 0xffff0000, v42
    v_fmac_f32 v10, v12, v86
    v_fmac_f32 v11, v13, v86
    v_lshlrev_b32 v12, 16, v43
    v_and_b32 v13, 0xffff0000, v43
    v_fmac_f32 v10, v12, v87
    v_fmac_f32 v11, v13, v87
    v_lshlrev_b32 v12, 16, v44
    v_and_b32 v13, 0xffff0000, v44
    v_fmac_f32 v10, v12, v88
    v_fmac_f32 v11, v13, v88
    v_lshlrev_b32 v12, 16, v45
    v_and_b32 v13, 0xffff0000, v45
    v_fmac_f32 v10, v12, v89
    v_fmac_f32 v11, v13, v89
    v_lshlrev_b32 v12, 16, v46
    v_and_b32 v13, 0xffff0000, v46
    v_fmac_f32 v10, v12, v90
    v_fmac_f32 v11, v13, v90
    v_lshlrev_b32 v12, 16, v47
    v_and_b32 v13, 0xffff0000, v47
    v_fmac_f32 v10, v12, v91
    v_fmac_f32 v11, v13, v91
    v_lshlrev_b32 v12, 16, v48
    v_and_b32 v13, 0xffff0000, v48
    v_fmac_f32 v10, v12, v92
    v_fmac_f32 v11, v13, v92
    v_lshlrev_b32 v12, 16, v49
    v_and_b32 v13, 0xffff0000, v49
    v_fmac_f32 v10, v12, v93
    v_fmac_f32 v11, v13, v93
    v_lshlrev_b32 v12, 16, v50
    v_and_b32 v13, 0xffff0000, v50
    v_fmac_f32 v10, v12, v94
    v_fmac_f32 v11, v13, v94
    v_lshlrev_b32 v12, 16, v51
    v_and_b32 v13, 0xffff0000, v51
    v_fmac_f32 v10, v12, v95
    v_fmac_f32 v11, v13, v95
    v_lshlrev_b32 v12, 9, v5
    v_lshl_add_u32 v12, v6, 3, v12
    ds_write_b64 v12, v[10:11] offset:4096
    s_waitcnt lgkmcnt(0)
    s_barrier
    v_cmp_gt_u32 vcc, 128, v0
    s_and_saveexec_b64 s[10:11], vcc
    s_cbranch_execz mod_end
    v_lshlrev_b32 v12, 2, v0

    ds_read_b32 v16, v12 offset:4096
    ds_read_b32 v17, v12 offset:4608
    ds_read_b32 v18, v12 offset:5120
    ds_read_b32 v19, v12 offset:5632
    ds_read_b32 v20, v12 offset:6144
    ds_read_b32 v21, v12 offset:6656
    ds_read_b32 v22, v12 offset:7168
    ds_read_b32 v23, v12 offset:7680
    ds_read_b32 v24, v12 offset:8192
    ds_read_b32 v25, v12 offset:8704
    ds_read_b32 v26, v12 offset:9216
    ds_read_b32 v27, v12 offset:9728
    ds_read_b32 v28, v12 offset:10240
    ds_read_b32 v29, v12 offset:10752
    ds_read_b32 v30, v12 offset:11264
    ds_read_b32 v31, v12 offset:11776
    s_waitcnt lgkmcnt(0)
    v_add_f32 v16, v16, v17
    v_add_f32 v16, v16, v18
    v_add_f32 v16, v16, v19
    v_add_f32 v16, v16, v20
    v_add_f32 v16, v16, v21
    v_add_f32 v16, v16, v22
    v_add_f32 v16, v16, v23
    v_add_f32 v16, v16, v24
    v_add_f32 v16, v16, v25
    v_add_f32 v16, v16, v26
    v_add_f32 v16, v16, v27
    v_add_f32 v16, v16, v28
    v_add_f32 v16, v16, v29
    v_add_f32 v16, v16, v30
    v_add_f32 v16, v16, v31
    v_cvt_pk_bf16_f32 v16, v16, v16
    v_lshlrev_b32 v16, 16, v16
    s_lshl_b32 s3, s2, 7
    v_add_u32 v13, s3, v0
    v_mov_b32 v14, 0
    v_subrev_u32 v15, 576, v13
    v_cmp_gt_u32 vcc, 576, v15
    v_cndmask_b32 v14, v14, 1.0, vcc
    v_subrev_u32 v15, 2304, v13
    v_cmp_gt_u32 vcc, 576, v15
    v_cndmask_b32 v14, v14, 1.0, vcc
    v_add_f32 v16, v16, v14
    v_cvt_pk_bf16_f32 v16, v16, v16
    v_lshlrev_b32 v16, 16, v16
    v_lshlrev_b32 v13, 2, v13
    buffer_store_dword v16, v13, s[20:23], 0 offen

mod_end:
    s_mov_b64 exec, s[10:11]
mod_done:
    s_endpgm

.globl ln1_kernel
.p2align 8
.type ln1_kernel,@function
ln1_kernel:
    s_cmp_ge_u32 s2, 256
    s_cbranch_scc1 ln1_kernel_done
    s_load_dwordx2 s[4:5], s[0:1], 0
    s_load_dwordx2 s[8:9], s[0:1], 88
    s_waitcnt lgkmcnt(0)

    s_mov_b32 s12, s4
    s_mov_b32 s13, s5
    s_mov_b32 s14, 2359296
    s_mov_b32 s15, 0x00020000
    s_add_u32 s16, s8, 1048576
    s_addc_u32 s17, s9, 0
    s_mov_b32 s18, 2359296
    s_mov_b32 s19, 0x00020000
    s_mov_b32 s20, s8
    s_mov_b32 s21, s9
    s_mov_b32 s22, 13824
    s_mov_b32 s23, 0x00020000
    v_and_b32 v1, 31, v0
    v_lshrrev_b32 v2, 5, v0
    s_lshl_b32 s3, s2, 3
    v_add_u32 v2, s3, v2
    v_mul_u32_u24 v3, 1152, v2
    v_lshl_add_u32 v3, v1, 2, v3
    v_lshlrev_b32 v4, 3, v1

    v_add_u32 v89, 2304, v4
    v_add_u32 v90, 0, v4
    buffer_load_dword v10, v3, s[12:15], 0 offen offset:0
    buffer_load_dword v11, v3, s[12:15], 0 offen offset:128
    buffer_load_dword v12, v3, s[12:15], 0 offen offset:256
    buffer_load_dword v13, v3, s[12:15], 0 offen offset:384
    buffer_load_dword v14, v3, s[12:15], 0 offen offset:512
    buffer_load_dword v15, v3, s[12:15], 0 offen offset:640
    buffer_load_dword v16, v3, s[12:15], 0 offen offset:768
    buffer_load_dword v17, v3, s[12:15], 0 offen offset:896
    buffer_load_dword v18, v3, s[12:15], 0 offen offset:1024
    buffer_load_dwordx2 v[40:41], v89, s[20:23], 0 offen offset:0
    buffer_load_dwordx2 v[60:61], v90, s[20:23], 0 offen offset:0
    buffer_load_dwordx2 v[42:43], v89, s[20:23], 0 offen offset:256
    buffer_load_dwordx2 v[62:63], v90, s[20:23], 0 offen offset:256
    buffer_load_dwordx2 v[44:45], v89, s[20:23], 0 offen offset:512
    buffer_load_dwordx2 v[64:65], v90, s[20:23], 0 offen offset:512
    buffer_load_dwordx2 v[46:47], v89, s[20:23], 0 offen offset:768
    buffer_load_dwordx2 v[66:67], v90, s[20:23], 0 offen offset:768
    buffer_load_dwordx2 v[48:49], v89, s[20:23], 0 offen offset:1024
    buffer_load_dwordx2 v[68:69], v90, s[20:23], 0 offen offset:1024
    buffer_load_dwordx2 v[50:51], v89, s[20:23], 0 offen offset:1280
    buffer_load_dwordx2 v[70:71], v90, s[20:23], 0 offen offset:1280
    buffer_load_dwordx2 v[52:53], v89, s[20:23], 0 offen offset:1536
    buffer_load_dwordx2 v[72:73], v90, s[20:23], 0 offen offset:1536
    buffer_load_dwordx2 v[54:55], v89, s[20:23], 0 offen offset:1792
    buffer_load_dwordx2 v[74:75], v90, s[20:23], 0 offen offset:1792
    buffer_load_dwordx2 v[56:57], v89, s[20:23], 0 offen offset:2048
    buffer_load_dwordx2 v[76:77], v90, s[20:23], 0 offen offset:2048
    s_add_u32 s24, s8, 4194304
    s_addc_u32 s25, s9, 0
    s_mov_b32 s26, 12582912
    s_mov_b32 s27, 0x00020000
    v_lshlrev_b32 v5, 11, v1
    v_add_u32 v5, v5, v2
    v_lshlrev_b32 v5, 6, v5
    v_add_u32 v5, 36, v5
    v_mov_b32 v80, 0
    v_mov_b32 v81, 0
    v_mov_b32 v82, 0
    v_mov_b32 v83, 0
    buffer_store_dwordx4 v[80:83], v5, s[24:27], 0 offen
    buffer_store_dwordx3 v[80:82], v5, s[24:27], 0 offen offset:16
    v_add_u32 v6, 0x400000, v5
    v_mov_b32 v84, 0x3f803f80
    v_mov_b32 v85, 0
    v_mov_b32 v86, 0
    v_mov_b32 v87, 0
    buffer_store_dwordx4 v[84:87], v6, s[24:27], 0 offen
    buffer_store_dwordx3 v[80:82], v6, s[24:27], 0 offen offset:16
    v_lshlrev_b32 v7, 5, v1
    v_add_u32 v7, 18, v7
    v_lshlrev_b32 v7, 12, v7
    v_lshl_add_u32 v7, v2, 1, v7
    v_add_u32 v7, 0x800000, v7
    v_mov_b32 v88, 0x3f80
    buffer_store_short v88, v7, s[24:27], 0 offen

    s_waitcnt vmcnt(23)
    v_lshlrev_b32 v20, 16, v10
    v_and_b32 v21, 0xffff0000, v10
    v_lshlrev_b32 v22, 16, v11
    v_and_b32 v23, 0xffff0000, v11
    v_lshlrev_b32 v24, 16, v12
    v_and_b32 v25, 0xffff0000, v12
    v_lshlrev_b32 v26, 16, v13
    v_and_b32 v27, 0xffff0000, v13
    v_lshlrev_b32 v28, 16, v14
    v_and_b32 v29, 0xffff0000, v14
    v_lshlrev_b32 v30, 16, v15
    v_and_b32 v31, 0xffff0000, v15
    v_lshlrev_b32 v32, 16, v16
    v_and_b32 v33, 0xffff0000, v16
    v_lshlrev_b32 v34, 16, v17
    v_and_b32 v35, 0xffff0000, v17
    v_lshlrev_b32 v36, 16, v18
    v_and_b32 v37, 0xffff0000, v18
    v_add_f32 v8, v20, v21
    v_add_f32 v8, v8, v22
    v_add_f32 v8, v8, v23
    v_add_f32 v8, v8, v24
    v_add_f32 v8, v8, v25
    v_add_f32 v8, v8, v26
    v_add_f32 v8, v8, v27
    v_add_f32 v8, v8, v28
    v_add_f32 v8, v8, v29
    v_add_f32 v8, v8, v30
    v_add_f32 v8, v8, v31
    v_add_f32 v8, v8, v32
    v_add_f32 v8, v8, v33
    v_add_f32 v8, v8, v34
    v_add_f32 v8, v8, v35
    v_add_f32 v8, v8, v36
    v_add_f32 v8, v8, v37
    ds_swizzle_b32 v9, v8 offset:1055
    s_waitcnt lgkmcnt(0)
    v_add_f32 v8, v8, v9
    ds_swizzle_b32 v9, v8 offset:2079
    s_waitcnt lgkmcnt(0)
    v_add_f32 v8, v8, v9
    ds_swizzle_b32 v9, v8 offset:4127
    s_waitcnt lgkmcnt(0)
    v_add_f32 v8, v8, v9
    ds_swizzle_b32 v9, v8 offset:8223
    s_waitcnt lgkmcnt(0)
    v_add_f32 v8, v8, v9
    ds_swizzle_b32 v9, v8 offset:16415
    s_waitcnt lgkmcnt(0)
    v_add_f32 v8, v8, v9
    v_mul_f32 v8, 0x3ae38e39, v8
    v_sub_f32 v20, v20, v8
    v_sub_f32 v21, v21, v8
    v_sub_f32 v22, v22, v8
    v_sub_f32 v23, v23, v8
    v_sub_f32 v24, v24, v8
    v_sub_f32 v25, v25, v8
    v_sub_f32 v26, v26, v8
    v_sub_f32 v27, v27, v8
    v_sub_f32 v28, v28, v8
    v_sub_f32 v29, v29, v8
    v_sub_f32 v30, v30, v8
    v_sub_f32 v31, v31, v8
    v_sub_f32 v32, v32, v8
    v_sub_f32 v33, v33, v8
    v_sub_f32 v34, v34, v8
    v_sub_f32 v35, v35, v8
    v_sub_f32 v36, v36, v8
    v_sub_f32 v37, v37, v8
    v_mul_f32 v8, v20, v20
    v_fmac_f32 v8, v21, v21
    v_fmac_f32 v8, v22, v22
    v_fmac_f32 v8, v23, v23
    v_fmac_f32 v8, v24, v24
    v_fmac_f32 v8, v25, v25
    v_fmac_f32 v8, v26, v26
    v_fmac_f32 v8, v27, v27
    v_fmac_f32 v8, v28, v28
    v_fmac_f32 v8, v29, v29
    v_fmac_f32 v8, v30, v30
    v_fmac_f32 v8, v31, v31
    v_fmac_f32 v8, v32, v32
    v_fmac_f32 v8, v33, v33
    v_fmac_f32 v8, v34, v34
    v_fmac_f32 v8, v35, v35
    v_fmac_f32 v8, v36, v36
    v_fmac_f32 v8, v37, v37
    ds_swizzle_b32 v9, v8 offset:1055
    s_waitcnt lgkmcnt(0)
    v_add_f32 v8, v8, v9
    ds_swizzle_b32 v9, v8 offset:2079
    s_waitcnt lgkmcnt(0)
    v_add_f32 v8, v8, v9
    ds_swizzle_b32 v9, v8 offset:4127
    s_waitcnt lgkmcnt(0)
    v_add_f32 v8, v8, v9
    ds_swizzle_b32 v9, v8 offset:8223
    s_waitcnt lgkmcnt(0)
    v_add_f32 v8, v8, v9
    ds_swizzle_b32 v9, v8 offset:16415
    s_waitcnt lgkmcnt(0)
    v_add_f32 v8, v8, v9
    v_mov_b32 v9, 0x3727c5ac
    v_fmac_f32 v9, 0x3ae38e39, v8
    v_rsq_f32 v9, v9
    s_waitcnt vmcnt(0)

    v_mul_f32 v20, v20, v9
    v_fma_f32 v20, v20, v40, v60
    v_mul_f32 v21, v21, v9
    v_fma_f32 v21, v21, v41, v61
    v_mul_f32 v22, v22, v9
    v_fma_f32 v22, v22, v42, v62
    v_mul_f32 v23, v23, v9
    v_fma_f32 v23, v23, v43, v63
    v_mul_f32 v24, v24, v9
    v_fma_f32 v24, v24, v44, v64
    v_mul_f32 v25, v25, v9
    v_fma_f32 v25, v25, v45, v65
    v_mul_f32 v26, v26, v9
    v_fma_f32 v26, v26, v46, v66
    v_mul_f32 v27, v27, v9
    v_fma_f32 v27, v27, v47, v67
    v_mul_f32 v28, v28, v9
    v_fma_f32 v28, v28, v48, v68
    v_mul_f32 v29, v29, v9
    v_fma_f32 v29, v29, v49, v69
    v_mul_f32 v30, v30, v9
    v_fma_f32 v30, v30, v50, v70
    v_mul_f32 v31, v31, v9
    v_fma_f32 v31, v31, v51, v71
    v_mul_f32 v32, v32, v9
    v_fma_f32 v32, v32, v52, v72
    v_mul_f32 v33, v33, v9
    v_fma_f32 v33, v33, v53, v73
    v_mul_f32 v34, v34, v9
    v_fma_f32 v34, v34, v54, v74
    v_mul_f32 v35, v35, v9
    v_fma_f32 v35, v35, v55, v75
    v_mul_f32 v36, v36, v9
    v_fma_f32 v36, v36, v56, v76
    v_mul_f32 v37, v37, v9
    v_fma_f32 v37, v37, v57, v77
    v_cvt_pk_bf16_f32 v10, v20, v21
    buffer_store_dword v10, v3, s[16:19], 0 offen offset:0
    v_cvt_pk_bf16_f32 v11, v22, v23
    buffer_store_dword v11, v3, s[16:19], 0 offen offset:128
    v_cvt_pk_bf16_f32 v12, v24, v25
    buffer_store_dword v12, v3, s[16:19], 0 offen offset:256
    v_cvt_pk_bf16_f32 v13, v26, v27
    buffer_store_dword v13, v3, s[16:19], 0 offen offset:384
    v_cvt_pk_bf16_f32 v14, v28, v29
    buffer_store_dword v14, v3, s[16:19], 0 offen offset:512
    v_cvt_pk_bf16_f32 v15, v30, v31
    buffer_store_dword v15, v3, s[16:19], 0 offen offset:640
    v_cvt_pk_bf16_f32 v16, v32, v33
    buffer_store_dword v16, v3, s[16:19], 0 offen offset:768
    v_cvt_pk_bf16_f32 v17, v34, v35
    buffer_store_dword v17, v3, s[16:19], 0 offen offset:896
    v_cvt_pk_bf16_f32 v18, v36, v37
    buffer_store_dword v18, v3, s[16:19], 0 offen offset:1024
ln1_kernel_done:
    s_endpgm

.globl qkv_kernel
.p2align 8
.type qkv_kernel,@function
qkv_kernel:
    s_cmp_ge_u32 s2, 224
    s_cbranch_scc1 qkv_kernel_done
    s_load_dwordx2 s[8:9], s[0:1], 88

    s_load_dwordx2 s[36:37], s[0:1], 8
    s_waitcnt lgkmcnt(0)
    s_add_u32 s12, s8, 1048576
    s_addc_u32 s13, s9, 0
    s_mov_b32 s14, 2359296
    s_mov_b32 s15, 0x00020000
    s_mov_b32 s16, s36
    s_mov_b32 s17, s37
    s_mov_b32 s18, 1990656
    s_mov_b32 s19, 0x00020000
    s_and_b32 s29, s2, 7
    s_mul_i32 s29, s29, 28
    s_lshr_b32 s30, s2, 3
    s_add_u32 s29, s29, s30
    s_mov_b32 s30, 306783379
    s_mul_hi_u32 s31, s29, s30
    s_mul_i32 s32, s31, 14
    s_sub_u32 s32, s29, s32

    s_mul_i32 s33, s31, 128
    s_mul_i32 s34, s32, 128
    v_and_b32 v1, 63, v0
    v_lshrrev_b32 v15, 6, v0
    s_nop 1
    v_readfirstlane_b32 s45, v15
    v_lshrrev_b32 v112, 2, v1
    v_and_b32 v113, 3, v1
    v_lshrrev_b32 v114, 4, v1
    v_xor_b32 v113, v113, v114
    v_lshl_add_u32 v115, v15, 4, v112
    v_add_u32 v115, s33, v115
    v_mov_b32 v116, 1152

    v_add_u32 v117, 0, v115
    v_mul_lo_u32 v2, v117, v116
    v_lshl_add_u32 v2, v113, 4, v2
    v_add_u32 v117, 64, v115
    v_mul_lo_u32 v3, v117, v116
    v_lshl_add_u32 v3, v113, 4, v3
    v_lshrrev_b32 v112, 4, v1
    v_and_b32 v113, 15, v1
    v_lshlrev_b32 v114, 2, v112
    v_xor_b32 v113, v113, v114
    v_lshl_add_u32 v115, v15, 2, v112

    v_mov_b32 v116, 3456
    s_lshl_b32 s35, s34, 1
    v_add_u32 v117, 0, v115
    v_mul_lo_u32 v4, v117, v116
    v_lshl_add_u32 v4, v113, 4, v4
    v_add_u32 v4, s35, v4
    v_add_u32 v117, 16, v115
    v_mul_lo_u32 v5, v117, v116
    v_lshl_add_u32 v5, v113, 4, v5
    v_add_u32 v5, s35, v5
    v_lshrrev_b32 v112, 1, v15
    v_and_b32 v113, 1, v15
    v_and_b32 v114, 31, v1
    v_lshrrev_b32 v115, 5, v1
    v_mul_u32_u24 v116, 64, v112
    v_add_u32 v116, v116, v114
    v_lshlrev_b32 v116, 6, v116
    v_lshrrev_b32 v117, 2, v114
    v_and_b32 v117, 3, v117
    v_xor_b32 v118, v115, v117
    v_lshl_add_u32 v6, v118, 4, v116
    v_xor_b32 v118, 2, v118
    v_lshl_add_u32 v7, v118, 4, v116

    v_and_b32 v117, 15, v1
    v_lshrrev_b32 v118, 2, v117
    v_lshl_add_u32 v119, v115, 3, v118
    v_mul_u32_u24 v119, 256, v119
    v_and_b32 v120, 3, v117
    v_and_b32 v121, 1, v120
    v_lshl_add_u32 v119, v121, 3, v119
    v_add_u32 v119, 8192, v119
    v_lshrrev_b32 v120, 1, v120
    v_lshrrev_b32 v121, 4, v1
    v_and_b32 v121, 1, v121
    v_lshl_add_u32 v120, v121, 1, v120
    v_lshl_add_u32 v120, v113, 3, v120

    v_lshlrev_b32 v121, 2, v118
    v_add_u32 v122, 0, v120
    v_xor_b32 v122, v122, v121
    v_lshl_add_u32 v8, v122, 4, v119
    v_add_u32 v122, 4, v120
    v_xor_b32 v122, v122, v121
    v_lshl_add_u32 v9, v122, 4, v119
    v_add_u32 v10, 0x10000, v6
    v_add_u32 v11, 0x10000, v7
    v_add_u32 v12, 0x10000, v8
    v_add_u32 v13, 0x10000, v9
    v_mov_b32 v48, 0
    v_mov_b32 v49, 0
    v_mov_b32 v50, 0
    v_mov_b32 v51, 0
    v_mov_b32 v52, 0
    v_mov_b32 v53, 0
    v_mov_b32 v54, 0
    v_mov_b32 v55, 0
    v_mov_b32 v56, 0
    v_mov_b32 v57, 0
    v_mov_b32 v58, 0
    v_mov_b32 v59, 0
    v_mov_b32 v60, 0
    v_mov_b32 v61, 0
    v_mov_b32 v62, 0
    v_mov_b32 v63, 0
    v_mov_b32 v64, 0
    v_mov_b32 v65, 0
    v_mov_b32 v66, 0
    v_mov_b32 v67, 0
    v_mov_b32 v68, 0
    v_mov_b32 v69, 0
    v_mov_b32 v70, 0
    v_mov_b32 v71, 0
    v_mov_b32 v72, 0
    v_mov_b32 v73, 0
    v_mov_b32 v74, 0
    v_mov_b32 v75, 0
    v_mov_b32 v76, 0
    v_mov_b32 v77, 0
    v_mov_b32 v78, 0
    v_mov_b32 v79, 0
    v_mov_b32 v80, 0
    v_mov_b32 v81, 0
    v_mov_b32 v82, 0
    v_mov_b32 v83, 0
    v_mov_b32 v84, 0
    v_mov_b32 v85, 0
    v_mov_b32 v86, 0
    v_mov_b32 v87, 0
    v_mov_b32 v88, 0
    v_mov_b32 v89, 0
    v_mov_b32 v90, 0
    v_mov_b32 v91, 0
    v_mov_b32 v92, 0
    v_mov_b32 v93, 0
    v_mov_b32 v94, 0
    v_mov_b32 v95, 0
    v_mov_b32 v96, 0
    v_mov_b32 v97, 0
    v_mov_b32 v98, 0
    v_mov_b32 v99, 0
    v_mov_b32 v100, 0
    v_mov_b32 v101, 0
    v_mov_b32 v102, 0
    v_mov_b32 v103, 0
    v_mov_b32 v104, 0
    v_mov_b32 v105, 0
    v_mov_b32 v106, 0
    v_mov_b32 v107, 0
    v_mov_b32 v108, 0
    v_mov_b32 v109, 0
    v_mov_b32 v110, 0
    v_mov_b32 v111, 0
    s_lshl_b32 s46, s45, 10
    s_mov_b32 s40, 0
    s_mov_b32 s41, 0
    s_add_u32 m0, s46, 0
    s_nop 0
    buffer_load_dwordx4 v2, s[12:15], s40 offen lds
    s_add_u32 m0, s46, 4096
    s_nop 0
    buffer_load_dwordx4 v3, s[12:15], s40 offen lds
    s_add_u32 m0, s46, 8192
    s_nop 0
    buffer_load_dwordx4 v4, s[16:19], s41 offen lds
    s_add_u32 m0, s46, 12288
    s_nop 0
    buffer_load_dwordx4 v5, s[16:19], s41 offen lds
    s_add_u32 s40, s40, 64
    s_add_u32 s41, s41, 110592
    s_add_u32 m0, s46, 16384
    s_nop 0
    buffer_load_dwordx4 v2, s[12:15], s40 offen lds
    s_add_u32 m0, s46, 20480
    s_nop 0
    buffer_load_dwordx4 v3, s[12:15], s40 offen lds
    s_add_u32 m0, s46, 24576
    s_nop 0
    buffer_load_dwordx4 v4, s[16:19], s41 offen lds
    s_add_u32 m0, s46, 28672
    s_nop 0
    buffer_load_dwordx4 v5, s[16:19], s41 offen lds
    s_add_u32 s40, s40, 64
    s_add_u32 s41, s41, 110592
    s_mov_b32 s42, 6
qkv_kernel_loop:
    s_waitcnt vmcnt(4)
    s_barrier
    ds_read_b128 v[16:19], v6 offset:0
    ds_read_b128 v[20:23], v6 offset:2048
    ds_read_b64_tr_b16 v[32:33], v8 offset:0
    ds_read_b64_tr_b16 v[34:35], v8 offset:1024
    ds_read_b64_tr_b16 v[36:37], v9 offset:0
    ds_read_b64_tr_b16 v[38:39], v9 offset:1024
    ds_read_b128 v[24:27], v7 offset:0
    ds_read_b128 v[28:31], v7 offset:2048
    ds_read_b64_tr_b16 v[40:41], v8 offset:4096
    ds_read_b64_tr_b16 v[42:43], v8 offset:5120
    ds_read_b64_tr_b16 v[44:45], v9 offset:4096
    ds_read_b64_tr_b16 v[46:47], v9 offset:5120
    s_add_u32 m0, s46, 32768
    s_nop 0
    buffer_load_dwordx4 v2, s[12:15], s40 offen lds
    s_add_u32 m0, s46, 36864
    s_nop 0
    buffer_load_dwordx4 v3, s[12:15], s40 offen lds
    s_add_u32 m0, s46, 40960
    s_nop 0
    buffer_load_dwordx4 v4, s[16:19], s41 offen lds
    s_add_u32 m0, s46, 45056
    s_nop 0
    buffer_load_dwordx4 v5, s[16:19], s41 offen lds
    s_add_u32 s40, s40, 64
    s_add_u32 s41, s41, 110592
    s_waitcnt lgkmcnt(6)
    v_mfma_f32_32x32x16_bf16 v[48:63], v[32:35], v[16:19], v[48:63]
    v_mfma_f32_32x32x16_bf16 v[64:79], v[36:39], v[16:19], v[64:79]
    v_mfma_f32_32x32x16_bf16 v[80:95], v[32:35], v[20:23], v[80:95]
    v_mfma_f32_32x32x16_bf16 v[96:111], v[36:39], v[20:23], v[96:111]
    s_waitcnt lgkmcnt(0)
    v_mfma_f32_32x32x16_bf16 v[48:63], v[40:43], v[24:27], v[48:63]
    v_mfma_f32_32x32x16_bf16 v[64:79], v[44:47], v[24:27], v[64:79]
    v_mfma_f32_32x32x16_bf16 v[80:95], v[40:43], v[28:31], v[80:95]
    v_mfma_f32_32x32x16_bf16 v[96:111], v[44:47], v[28:31], v[96:111]
    s_waitcnt vmcnt(4)
    s_barrier
    ds_read_b128 v[16:19], v6 offset:16384
    ds_read_b128 v[20:23], v6 offset:18432
    ds_read_b64_tr_b16 v[32:33], v8 offset:16384
    ds_read_b64_tr_b16 v[34:35], v8 offset:17408
    ds_read_b64_tr_b16 v[36:37], v9 offset:16384
    ds_read_b64_tr_b16 v[38:39], v9 offset:17408
    ds_read_b128 v[24:27], v7 offset:16384
    ds_read_b128 v[28:31], v7 offset:18432
    ds_read_b64_tr_b16 v[40:41], v8 offset:20480
    ds_read_b64_tr_b16 v[42:43], v8 offset:21504
    ds_read_b64_tr_b16 v[44:45], v9 offset:20480
    ds_read_b64_tr_b16 v[46:47], v9 offset:21504
    s_add_u32 m0, s46, 0
    s_nop 0
    buffer_load_dwordx4 v2, s[12:15], s40 offen lds
    s_add_u32 m0, s46, 4096
    s_nop 0
    buffer_load_dwordx4 v3, s[12:15], s40 offen lds
    s_add_u32 m0, s46, 8192
    s_nop 0
    buffer_load_dwordx4 v4, s[16:19], s41 offen lds
    s_add_u32 m0, s46, 12288
    s_nop 0
    buffer_load_dwordx4 v5, s[16:19], s41 offen lds
    s_add_u32 s40, s40, 64
    s_add_u32 s41, s41, 110592
    s_waitcnt lgkmcnt(6)
    v_mfma_f32_32x32x16_bf16 v[48:63], v[32:35], v[16:19], v[48:63]
    v_mfma_f32_32x32x16_bf16 v[64:79], v[36:39], v[16:19], v[64:79]
    v_mfma_f32_32x32x16_bf16 v[80:95], v[32:35], v[20:23], v[80:95]
    v_mfma_f32_32x32x16_bf16 v[96:111], v[36:39], v[20:23], v[96:111]
    s_waitcnt lgkmcnt(0)
    v_mfma_f32_32x32x16_bf16 v[48:63], v[40:43], v[24:27], v[48:63]
    v_mfma_f32_32x32x16_bf16 v[64:79], v[44:47], v[24:27], v[64:79]
    v_mfma_f32_32x32x16_bf16 v[80:95], v[40:43], v[28:31], v[80:95]
    v_mfma_f32_32x32x16_bf16 v[96:111], v[44:47], v[28:31], v[96:111]
    s_waitcnt vmcnt(4)
    s_barrier
    ds_read_b128 v[16:19], v6 offset:32768
    ds_read_b128 v[20:23], v6 offset:34816
    ds_read_b64_tr_b16 v[32:33], v8 offset:32768
    ds_read_b64_tr_b16 v[34:35], v8 offset:33792
    ds_read_b64_tr_b16 v[36:37], v9 offset:32768
    ds_read_b64_tr_b16 v[38:39], v9 offset:33792
    ds_read_b128 v[24:27], v7 offset:32768
    ds_read_b128 v[28:31], v7 offset:34816
    ds_read_b64_tr_b16 v[40:41], v8 offset:36864
    ds_read_b64_tr_b16 v[42:43], v8 offset:37888
    ds_read_b64_tr_b16 v[44:45], v9 offset:36864
    ds_read_b64_tr_b16 v[46:47], v9 offset:37888
    s_add_u32 m0, s46, 16384
    s_nop 0
    buffer_load_dwordx4 v2, s[12:15], s40 offen lds
    s_add_u32 m0, s46, 20480
    s_nop 0
    buffer_load_dwordx4 v3, s[12:15], s40 offen lds
    s_add_u32 m0, s46, 24576
    s_nop 0
    buffer_load_dwordx4 v4, s[16:19], s41 offen lds
    s_add_u32 m0, s46, 28672
    s_nop 0
    buffer_load_dwordx4 v5, s[16:19], s41 offen lds
    s_add_u32 s40, s40, 64
    s_add_u32 s41, s41, 110592
    s_waitcnt lgkmcnt(6)
    v_mfma_f32_32x32x16_bf16 v[48:63], v[32:35], v[16:19], v[48:63]
    v_mfma_f32_32x32x16_bf16 v[64:79], v[36:39], v[16:19], v[64:79]
    v_mfma_f32_32x32x16_bf16 v[80:95], v[32:35], v[20:23], v[80:95]
    v_mfma_f32_32x32x16_bf16 v[96:111], v[36:39], v[20:23], v[96:111]
    s_waitcnt lgkmcnt(0)
    v_mfma_f32_32x32x16_bf16 v[48:63], v[40:43], v[24:27], v[48:63]
    v_mfma_f32_32x32x16_bf16 v[64:79], v[44:47], v[24:27], v[64:79]
    v_mfma_f32_32x32x16_bf16 v[80:95], v[40:43], v[28:31], v[80:95]
    v_mfma_f32_32x32x16_bf16 v[96:111], v[44:47], v[28:31], v[96:111]
    s_sub_u32 s42, s42, 1
    s_cmp_lg_u32 s42, 0
    s_cbranch_scc1 qkv_kernel_loop
    s_waitcnt vmcnt(0)
    s_nop 15
    v_lshrrev_b32 v112, 1, v15
    v_and_b32 v113, 1, v15
    v_and_b32 v114, 31, v1
    v_lshrrev_b32 v115, 5, v1
    v_mul_u32_u24 v116, 64, v112
    v_add3_u32 v116, v116, v114, s33
    v_mul_u32_u24 v117, 64, v113
    v_lshl_add_u32 v117, v115, 2, v117
    v_add_u32 v117, s34, v117

    s_add_u32 s28, s8, 4194304
    s_addc_u32 s29, s9, 0
    s_mov_b32 s30, 12582912
    s_mov_b32 s31, 0x00020000
    s_mov_b32 s43, 3641
    s_mov_b32 s44, 0x3ead8bd9
    v_add_u32 v119, 0, v116
    v_lshlrev_b32 v132, 6, v119
    v_and_b32 v133, 4, v119
    v_and_b32 v134, 8, v119
    v_and_b32 v135, 0xfffffff3, v119
    v_lshl_add_u32 v135, v133, 1, v135
    v_lshrrev_b32 v134, 1, v134
    v_add_u32 v135, v135, v134
    v_lshlrev_b32 v135, 1, v135
    v_add_u32 v118, 0, v117
    v_mul_u32_u24 v120, s43, v118
    v_lshrrev_b32 v120, 16, v120
    v_mul_u32_u24 v121, 18, v120
    v_sub_u32 v121, v118, v121
    v_lshlrev_b32 v122, 17, v120
    v_lshl_add_u32 v123, v121, 12, v122
    v_lshl_add_u32 v122, v121, 1, v122
    v_add_u32 v122, v122, v132
    v_add_u32 v123, v123, v135
    v_cmp_gt_u32 vcc, 64, v120
    v_cndmask_b32 v122, v123, v122, vcc
    v_mul_f32 v124, s44, v48
    v_cmp_gt_u32 vcc, 32, v120
    v_cndmask_b32 v124, v48, v124, vcc
    v_cvt_pk_bf16_f32 v124, v124, v124
    v_cmp_gt_u32 vcc, 1728, v118
    v_cndmask_b32 v122, -1, v122, vcc
    buffer_store_short v124, v122, s[28:31], 0 offen
    v_add_u32 v118, 1, v117
    v_mul_u32_u24 v120, s43, v118
    v_lshrrev_b32 v120, 16, v120
    v_mul_u32_u24 v121, 18, v120
    v_sub_u32 v121, v118, v121
    v_lshlrev_b32 v122, 17, v120
    v_lshl_add_u32 v123, v121, 12, v122
    v_lshl_add_u32 v122, v121, 1, v122
    v_add_u32 v122, v122, v132
    v_add_u32 v123, v123, v135
    v_cmp_gt_u32 vcc, 64, v120
    v_cndmask_b32 v122, v123, v122, vcc
    v_mul_f32 v124, s44, v49
    v_cmp_gt_u32 vcc, 32, v120
    v_cndmask_b32 v124, v49, v124, vcc
    v_cvt_pk_bf16_f32 v124, v124, v124
    v_cmp_gt_u32 vcc, 1728, v118
    v_cndmask_b32 v122, -1, v122, vcc
    buffer_store_short v124, v122, s[28:31], 0 offen
    v_add_u32 v118, 2, v117
    v_mul_u32_u24 v120, s43, v118
    v_lshrrev_b32 v120, 16, v120
    v_mul_u32_u24 v121, 18, v120
    v_sub_u32 v121, v118, v121
    v_lshlrev_b32 v122, 17, v120
    v_lshl_add_u32 v123, v121, 12, v122
    v_lshl_add_u32 v122, v121, 1, v122
    v_add_u32 v122, v122, v132
    v_add_u32 v123, v123, v135
    v_cmp_gt_u32 vcc, 64, v120
    v_cndmask_b32 v122, v123, v122, vcc
    v_mul_f32 v124, s44, v50
    v_cmp_gt_u32 vcc, 32, v120
    v_cndmask_b32 v124, v50, v124, vcc
    v_cvt_pk_bf16_f32 v124, v124, v124
    v_cmp_gt_u32 vcc, 1728, v118
    v_cndmask_b32 v122, -1, v122, vcc
    buffer_store_short v124, v122, s[28:31], 0 offen
    v_add_u32 v118, 3, v117
    v_mul_u32_u24 v120, s43, v118
    v_lshrrev_b32 v120, 16, v120
    v_mul_u32_u24 v121, 18, v120
    v_sub_u32 v121, v118, v121
    v_lshlrev_b32 v122, 17, v120
    v_lshl_add_u32 v123, v121, 12, v122
    v_lshl_add_u32 v122, v121, 1, v122
    v_add_u32 v122, v122, v132
    v_add_u32 v123, v123, v135
    v_cmp_gt_u32 vcc, 64, v120
    v_cndmask_b32 v122, v123, v122, vcc
    v_mul_f32 v124, s44, v51
    v_cmp_gt_u32 vcc, 32, v120
    v_cndmask_b32 v124, v51, v124, vcc
    v_cvt_pk_bf16_f32 v124, v124, v124
    v_cmp_gt_u32 vcc, 1728, v118
    v_cndmask_b32 v122, -1, v122, vcc
    buffer_store_short v124, v122, s[28:31], 0 offen
    v_add_u32 v118, 8, v117
    v_mul_u32_u24 v120, s43, v118
    v_lshrrev_b32 v120, 16, v120
    v_mul_u32_u24 v121, 18, v120
    v_sub_u32 v121, v118, v121
    v_lshlrev_b32 v122, 17, v120
    v_lshl_add_u32 v123, v121, 12, v122
    v_lshl_add_u32 v122, v121, 1, v122
    v_add_u32 v122, v122, v132
    v_add_u32 v123, v123, v135
    v_cmp_gt_u32 vcc, 64, v120
    v_cndmask_b32 v122, v123, v122, vcc
    v_mul_f32 v124, s44, v52
    v_cmp_gt_u32 vcc, 32, v120
    v_cndmask_b32 v124, v52, v124, vcc
    v_cvt_pk_bf16_f32 v124, v124, v124
    v_cmp_gt_u32 vcc, 1728, v118
    v_cndmask_b32 v122, -1, v122, vcc
    buffer_store_short v124, v122, s[28:31], 0 offen
    v_add_u32 v118, 9, v117
    v_mul_u32_u24 v120, s43, v118
    v_lshrrev_b32 v120, 16, v120
    v_mul_u32_u24 v121, 18, v120
    v_sub_u32 v121, v118, v121
    v_lshlrev_b32 v122, 17, v120
    v_lshl_add_u32 v123, v121, 12, v122
    v_lshl_add_u32 v122, v121, 1, v122
    v_add_u32 v122, v122, v132
    v_add_u32 v123, v123, v135
    v_cmp_gt_u32 vcc, 64, v120
    v_cndmask_b32 v122, v123, v122, vcc
    v_mul_f32 v124, s44, v53
    v_cmp_gt_u32 vcc, 32, v120
    v_cndmask_b32 v124, v53, v124, vcc
    v_cvt_pk_bf16_f32 v124, v124, v124
    v_cmp_gt_u32 vcc, 1728, v118
    v_cndmask_b32 v122, -1, v122, vcc
    buffer_store_short v124, v122, s[28:31], 0 offen
    v_add_u32 v118, 10, v117
    v_mul_u32_u24 v120, s43, v118
    v_lshrrev_b32 v120, 16, v120
    v_mul_u32_u24 v121, 18, v120
    v_sub_u32 v121, v118, v121
    v_lshlrev_b32 v122, 17, v120
    v_lshl_add_u32 v123, v121, 12, v122
    v_lshl_add_u32 v122, v121, 1, v122
    v_add_u32 v122, v122, v132
    v_add_u32 v123, v123, v135
    v_cmp_gt_u32 vcc, 64, v120
    v_cndmask_b32 v122, v123, v122, vcc
    v_mul_f32 v124, s44, v54
    v_cmp_gt_u32 vcc, 32, v120
    v_cndmask_b32 v124, v54, v124, vcc
    v_cvt_pk_bf16_f32 v124, v124, v124
    v_cmp_gt_u32 vcc, 1728, v118
    v_cndmask_b32 v122, -1, v122, vcc
    buffer_store_short v124, v122, s[28:31], 0 offen
    v_add_u32 v118, 11, v117
    v_mul_u32_u24 v120, s43, v118
    v_lshrrev_b32 v120, 16, v120
    v_mul_u32_u24 v121, 18, v120
    v_sub_u32 v121, v118, v121
    v_lshlrev_b32 v122, 17, v120
    v_lshl_add_u32 v123, v121, 12, v122
    v_lshl_add_u32 v122, v121, 1, v122
    v_add_u32 v122, v122, v132
    v_add_u32 v123, v123, v135
    v_cmp_gt_u32 vcc, 64, v120
    v_cndmask_b32 v122, v123, v122, vcc
    v_mul_f32 v124, s44, v55
    v_cmp_gt_u32 vcc, 32, v120
    v_cndmask_b32 v124, v55, v124, vcc
    v_cvt_pk_bf16_f32 v124, v124, v124
    v_cmp_gt_u32 vcc, 1728, v118
    v_cndmask_b32 v122, -1, v122, vcc
    buffer_store_short v124, v122, s[28:31], 0 offen
    v_add_u32 v118, 16, v117
    v_mul_u32_u24 v120, s43, v118
    v_lshrrev_b32 v120, 16, v120
    v_mul_u32_u24 v121, 18, v120
    v_sub_u32 v121, v118, v121
    v_lshlrev_b32 v122, 17, v120
    v_lshl_add_u32 v123, v121, 12, v122
    v_lshl_add_u32 v122, v121, 1, v122
    v_add_u32 v122, v122, v132
    v_add_u32 v123, v123, v135
    v_cmp_gt_u32 vcc, 64, v120
    v_cndmask_b32 v122, v123, v122, vcc
    v_mul_f32 v124, s44, v56
    v_cmp_gt_u32 vcc, 32, v120
    v_cndmask_b32 v124, v56, v124, vcc
    v_cvt_pk_bf16_f32 v124, v124, v124
    v_cmp_gt_u32 vcc, 1728, v118
    v_cndmask_b32 v122, -1, v122, vcc
    buffer_store_short v124, v122, s[28:31], 0 offen
    v_add_u32 v118, 17, v117
    v_mul_u32_u24 v120, s43, v118
    v_lshrrev_b32 v120, 16, v120
    v_mul_u32_u24 v121, 18, v120
    v_sub_u32 v121, v118, v121
    v_lshlrev_b32 v122, 17, v120
    v_lshl_add_u32 v123, v121, 12, v122
    v_lshl_add_u32 v122, v121, 1, v122
    v_add_u32 v122, v122, v132
    v_add_u32 v123, v123, v135
    v_cmp_gt_u32 vcc, 64, v120
    v_cndmask_b32 v122, v123, v122, vcc
    v_mul_f32 v124, s44, v57
    v_cmp_gt_u32 vcc, 32, v120
    v_cndmask_b32 v124, v57, v124, vcc
    v_cvt_pk_bf16_f32 v124, v124, v124
    v_cmp_gt_u32 vcc, 1728, v118
    v_cndmask_b32 v122, -1, v122, vcc
    buffer_store_short v124, v122, s[28:31], 0 offen
    v_add_u32 v118, 18, v117
    v_mul_u32_u24 v120, s43, v118
    v_lshrrev_b32 v120, 16, v120
    v_mul_u32_u24 v121, 18, v120
    v_sub_u32 v121, v118, v121
    v_lshlrev_b32 v122, 17, v120
    v_lshl_add_u32 v123, v121, 12, v122
    v_lshl_add_u32 v122, v121, 1, v122
    v_add_u32 v122, v122, v132
    v_add_u32 v123, v123, v135
    v_cmp_gt_u32 vcc, 64, v120
    v_cndmask_b32 v122, v123, v122, vcc
    v_mul_f32 v124, s44, v58
    v_cmp_gt_u32 vcc, 32, v120
    v_cndmask_b32 v124, v58, v124, vcc
    v_cvt_pk_bf16_f32 v124, v124, v124
    v_cmp_gt_u32 vcc, 1728, v118
    v_cndmask_b32 v122, -1, v122, vcc
    buffer_store_short v124, v122, s[28:31], 0 offen
    v_add_u32 v118, 19, v117
    v_mul_u32_u24 v120, s43, v118
    v_lshrrev_b32 v120, 16, v120
    v_mul_u32_u24 v121, 18, v120
    v_sub_u32 v121, v118, v121
    v_lshlrev_b32 v122, 17, v120
    v_lshl_add_u32 v123, v121, 12, v122
    v_lshl_add_u32 v122, v121, 1, v122
    v_add_u32 v122, v122, v132
    v_add_u32 v123, v123, v135
    v_cmp_gt_u32 vcc, 64, v120
    v_cndmask_b32 v122, v123, v122, vcc
    v_mul_f32 v124, s44, v59
    v_cmp_gt_u32 vcc, 32, v120
    v_cndmask_b32 v124, v59, v124, vcc
    v_cvt_pk_bf16_f32 v124, v124, v124
    v_cmp_gt_u32 vcc, 1728, v118
    v_cndmask_b32 v122, -1, v122, vcc
    buffer_store_short v124, v122, s[28:31], 0 offen
    v_add_u32 v118, 24, v117
    v_mul_u32_u24 v120, s43, v118
    v_lshrrev_b32 v120, 16, v120
    v_mul_u32_u24 v121, 18, v120
    v_sub_u32 v121, v118, v121
    v_lshlrev_b32 v122, 17, v120
    v_lshl_add_u32 v123, v121, 12, v122
    v_lshl_add_u32 v122, v121, 1, v122
    v_add_u32 v122, v122, v132
    v_add_u32 v123, v123, v135
    v_cmp_gt_u32 vcc, 64, v120
    v_cndmask_b32 v122, v123, v122, vcc
    v_mul_f32 v124, s44, v60
    v_cmp_gt_u32 vcc, 32, v120
    v_cndmask_b32 v124, v60, v124, vcc
    v_cvt_pk_bf16_f32 v124, v124, v124
    v_cmp_gt_u32 vcc, 1728, v118
    v_cndmask_b32 v122, -1, v122, vcc
    buffer_store_short v124, v122, s[28:31], 0 offen
    v_add_u32 v118, 25, v117
    v_mul_u32_u24 v120, s43, v118
    v_lshrrev_b32 v120, 16, v120
    v_mul_u32_u24 v121, 18, v120
    v_sub_u32 v121, v118, v121
    v_lshlrev_b32 v122, 17, v120
    v_lshl_add_u32 v123, v121, 12, v122
    v_lshl_add_u32 v122, v121, 1, v122
    v_add_u32 v122, v122, v132
    v_add_u32 v123, v123, v135
    v_cmp_gt_u32 vcc, 64, v120
    v_cndmask_b32 v122, v123, v122, vcc
    v_mul_f32 v124, s44, v61
    v_cmp_gt_u32 vcc, 32, v120
    v_cndmask_b32 v124, v61, v124, vcc
    v_cvt_pk_bf16_f32 v124, v124, v124
    v_cmp_gt_u32 vcc, 1728, v118
    v_cndmask_b32 v122, -1, v122, vcc
    buffer_store_short v124, v122, s[28:31], 0 offen
    v_add_u32 v118, 26, v117
    v_mul_u32_u24 v120, s43, v118
    v_lshrrev_b32 v120, 16, v120
    v_mul_u32_u24 v121, 18, v120
    v_sub_u32 v121, v118, v121
    v_lshlrev_b32 v122, 17, v120
    v_lshl_add_u32 v123, v121, 12, v122
    v_lshl_add_u32 v122, v121, 1, v122
    v_add_u32 v122, v122, v132
    v_add_u32 v123, v123, v135
    v_cmp_gt_u32 vcc, 64, v120
    v_cndmask_b32 v122, v123, v122, vcc
    v_mul_f32 v124, s44, v62
    v_cmp_gt_u32 vcc, 32, v120
    v_cndmask_b32 v124, v62, v124, vcc
    v_cvt_pk_bf16_f32 v124, v124, v124
    v_cmp_gt_u32 vcc, 1728, v118
    v_cndmask_b32 v122, -1, v122, vcc
    buffer_store_short v124, v122, s[28:31], 0 offen
    v_add_u32 v118, 27, v117
    v_mul_u32_u24 v120, s43, v118
    v_lshrrev_b32 v120, 16, v120
    v_mul_u32_u24 v121, 18, v120
    v_sub_u32 v121, v118, v121
    v_lshlrev_b32 v122, 17, v120
    v_lshl_add_u32 v123, v121, 12, v122
    v_lshl_add_u32 v122, v121, 1, v122
    v_add_u32 v122, v122, v132
    v_add_u32 v123, v123, v135
    v_cmp_gt_u32 vcc, 64, v120
    v_cndmask_b32 v122, v123, v122, vcc
    v_mul_f32 v124, s44, v63
    v_cmp_gt_u32 vcc, 32, v120
    v_cndmask_b32 v124, v63, v124, vcc
    v_cvt_pk_bf16_f32 v124, v124, v124
    v_cmp_gt_u32 vcc, 1728, v118
    v_cndmask_b32 v122, -1, v122, vcc
    buffer_store_short v124, v122, s[28:31], 0 offen
    v_add_u32 v118, 32, v117
    v_mul_u32_u24 v120, s43, v118
    v_lshrrev_b32 v120, 16, v120
    v_mul_u32_u24 v121, 18, v120
    v_sub_u32 v121, v118, v121
    v_lshlrev_b32 v122, 17, v120
    v_lshl_add_u32 v123, v121, 12, v122
    v_lshl_add_u32 v122, v121, 1, v122
    v_add_u32 v122, v122, v132
    v_add_u32 v123, v123, v135
    v_cmp_gt_u32 vcc, 64, v120
    v_cndmask_b32 v122, v123, v122, vcc
    v_mul_f32 v124, s44, v64
    v_cmp_gt_u32 vcc, 32, v120
    v_cndmask_b32 v124, v64, v124, vcc
    v_cvt_pk_bf16_f32 v124, v124, v124
    v_cmp_gt_u32 vcc, 1728, v118
    v_cndmask_b32 v122, -1, v122, vcc
    buffer_store_short v124, v122, s[28:31], 0 offen
    v_add_u32 v118, 33, v117
    v_mul_u32_u24 v120, s43, v118
    v_lshrrev_b32 v120, 16, v120
    v_mul_u32_u24 v121, 18, v120
    v_sub_u32 v121, v118, v121
    v_lshlrev_b32 v122, 17, v120
    v_lshl_add_u32 v123, v121, 12, v122
    v_lshl_add_u32 v122, v121, 1, v122
    v_add_u32 v122, v122, v132
    v_add_u32 v123, v123, v135
    v_cmp_gt_u32 vcc, 64, v120
    v_cndmask_b32 v122, v123, v122, vcc
    v_mul_f32 v124, s44, v65
    v_cmp_gt_u32 vcc, 32, v120
    v_cndmask_b32 v124, v65, v124, vcc
    v_cvt_pk_bf16_f32 v124, v124, v124
    v_cmp_gt_u32 vcc, 1728, v118
    v_cndmask_b32 v122, -1, v122, vcc
    buffer_store_short v124, v122, s[28:31], 0 offen
    v_add_u32 v118, 34, v117
    v_mul_u32_u24 v120, s43, v118
    v_lshrrev_b32 v120, 16, v120
    v_mul_u32_u24 v121, 18, v120
    v_sub_u32 v121, v118, v121
    v_lshlrev_b32 v122, 17, v120
    v_lshl_add_u32 v123, v121, 12, v122
    v_lshl_add_u32 v122, v121, 1, v122
    v_add_u32 v122, v122, v132
    v_add_u32 v123, v123, v135
    v_cmp_gt_u32 vcc, 64, v120
    v_cndmask_b32 v122, v123, v122, vcc
    v_mul_f32 v124, s44, v66
    v_cmp_gt_u32 vcc, 32, v120
    v_cndmask_b32 v124, v66, v124, vcc
    v_cvt_pk_bf16_f32 v124, v124, v124
    v_cmp_gt_u32 vcc, 1728, v118
    v_cndmask_b32 v122, -1, v122, vcc
    buffer_store_short v124, v122, s[28:31], 0 offen
    v_add_u32 v118, 35, v117
    v_mul_u32_u24 v120, s43, v118
    v_lshrrev_b32 v120, 16, v120
    v_mul_u32_u24 v121, 18, v120
    v_sub_u32 v121, v118, v121
    v_lshlrev_b32 v122, 17, v120
    v_lshl_add_u32 v123, v121, 12, v122
    v_lshl_add_u32 v122, v121, 1, v122
    v_add_u32 v122, v122, v132
    v_add_u32 v123, v123, v135
    v_cmp_gt_u32 vcc, 64, v120
    v_cndmask_b32 v122, v123, v122, vcc
    v_mul_f32 v124, s44, v67
    v_cmp_gt_u32 vcc, 32, v120
    v_cndmask_b32 v124, v67, v124, vcc
    v_cvt_pk_bf16_f32 v124, v124, v124
    v_cmp_gt_u32 vcc, 1728, v118
    v_cndmask_b32 v122, -1, v122, vcc
    buffer_store_short v124, v122, s[28:31], 0 offen
    v_add_u32 v118, 40, v117
    v_mul_u32_u24 v120, s43, v118
    v_lshrrev_b32 v120, 16, v120
    v_mul_u32_u24 v121, 18, v120
    v_sub_u32 v121, v118, v121
    v_lshlrev_b32 v122, 17, v120
    v_lshl_add_u32 v123, v121, 12, v122
    v_lshl_add_u32 v122, v121, 1, v122
    v_add_u32 v122, v122, v132
    v_add_u32 v123, v123, v135
    v_cmp_gt_u32 vcc, 64, v120
    v_cndmask_b32 v122, v123, v122, vcc
    v_mul_f32 v124, s44, v68
    v_cmp_gt_u32 vcc, 32, v120
    v_cndmask_b32 v124, v68, v124, vcc
    v_cvt_pk_bf16_f32 v124, v124, v124
    v_cmp_gt_u32 vcc, 1728, v118
    v_cndmask_b32 v122, -1, v122, vcc
    buffer_store_short v124, v122, s[28:31], 0 offen
    v_add_u32 v118, 41, v117
    v_mul_u32_u24 v120, s43, v118
    v_lshrrev_b32 v120, 16, v120
    v_mul_u32_u24 v121, 18, v120
    v_sub_u32 v121, v118, v121
    v_lshlrev_b32 v122, 17, v120
    v_lshl_add_u32 v123, v121, 12, v122
    v_lshl_add_u32 v122, v121, 1, v122
    v_add_u32 v122, v122, v132
    v_add_u32 v123, v123, v135
    v_cmp_gt_u32 vcc, 64, v120
    v_cndmask_b32 v122, v123, v122, vcc
    v_mul_f32 v124, s44, v69
    v_cmp_gt_u32 vcc, 32, v120
    v_cndmask_b32 v124, v69, v124, vcc
    v_cvt_pk_bf16_f32 v124, v124, v124
    v_cmp_gt_u32 vcc, 1728, v118
    v_cndmask_b32 v122, -1, v122, vcc
    buffer_store_short v124, v122, s[28:31], 0 offen
    v_add_u32 v118, 42, v117
    v_mul_u32_u24 v120, s43, v118
    v_lshrrev_b32 v120, 16, v120
    v_mul_u32_u24 v121, 18, v120
    v_sub_u32 v121, v118, v121
    v_lshlrev_b32 v122, 17, v120
    v_lshl_add_u32 v123, v121, 12, v122
    v_lshl_add_u32 v122, v121, 1, v122
    v_add_u32 v122, v122, v132
    v_add_u32 v123, v123, v135
    v_cmp_gt_u32 vcc, 64, v120
    v_cndmask_b32 v122, v123, v122, vcc
    v_mul_f32 v124, s44, v70
    v_cmp_gt_u32 vcc, 32, v120
    v_cndmask_b32 v124, v70, v124, vcc
    v_cvt_pk_bf16_f32 v124, v124, v124
    v_cmp_gt_u32 vcc, 1728, v118
    v_cndmask_b32 v122, -1, v122, vcc
    buffer_store_short v124, v122, s[28:31], 0 offen
    v_add_u32 v118, 43, v117
    v_mul_u32_u24 v120, s43, v118
    v_lshrrev_b32 v120, 16, v120
    v_mul_u32_u24 v121, 18, v120
    v_sub_u32 v121, v118, v121
    v_lshlrev_b32 v122, 17, v120
    v_lshl_add_u32 v123, v121, 12, v122
    v_lshl_add_u32 v122, v121, 1, v122
    v_add_u32 v122, v122, v132
    v_add_u32 v123, v123, v135
    v_cmp_gt_u32 vcc, 64, v120
    v_cndmask_b32 v122, v123, v122, vcc
    v_mul_f32 v124, s44, v71
    v_cmp_gt_u32 vcc, 32, v120
    v_cndmask_b32 v124, v71, v124, vcc
    v_cvt_pk_bf16_f32 v124, v124, v124
    v_cmp_gt_u32 vcc, 1728, v118
    v_cndmask_b32 v122, -1, v122, vcc
    buffer_store_short v124, v122, s[28:31], 0 offen
    v_add_u32 v118, 48, v117
    v_mul_u32_u24 v120, s43, v118
    v_lshrrev_b32 v120, 16, v120
    v_mul_u32_u24 v121, 18, v120
    v_sub_u32 v121, v118, v121
    v_lshlrev_b32 v122, 17, v120
    v_lshl_add_u32 v123, v121, 12, v122
    v_lshl_add_u32 v122, v121, 1, v122
    v_add_u32 v122, v122, v132
    v_add_u32 v123, v123, v135
    v_cmp_gt_u32 vcc, 64, v120
    v_cndmask_b32 v122, v123, v122, vcc
    v_mul_f32 v124, s44, v72
    v_cmp_gt_u32 vcc, 32, v120
    v_cndmask_b32 v124, v72, v124, vcc
    v_cvt_pk_bf16_f32 v124, v124, v124
    v_cmp_gt_u32 vcc, 1728, v118
    v_cndmask_b32 v122, -1, v122, vcc
    buffer_store_short v124, v122, s[28:31], 0 offen
    v_add_u32 v118, 49, v117
    v_mul_u32_u24 v120, s43, v118
    v_lshrrev_b32 v120, 16, v120
    v_mul_u32_u24 v121, 18, v120
    v_sub_u32 v121, v118, v121
    v_lshlrev_b32 v122, 17, v120
    v_lshl_add_u32 v123, v121, 12, v122
    v_lshl_add_u32 v122, v121, 1, v122
    v_add_u32 v122, v122, v132
    v_add_u32 v123, v123, v135
    v_cmp_gt_u32 vcc, 64, v120
    v_cndmask_b32 v122, v123, v122, vcc
    v_mul_f32 v124, s44, v73
    v_cmp_gt_u32 vcc, 32, v120
    v_cndmask_b32 v124, v73, v124, vcc
    v_cvt_pk_bf16_f32 v124, v124, v124
    v_cmp_gt_u32 vcc, 1728, v118
    v_cndmask_b32 v122, -1, v122, vcc
    buffer_store_short v124, v122, s[28:31], 0 offen
    v_add_u32 v118, 50, v117
    v_mul_u32_u24 v120, s43, v118
    v_lshrrev_b32 v120, 16, v120
    v_mul_u32_u24 v121, 18, v120
    v_sub_u32 v121, v118, v121
    v_lshlrev_b32 v122, 17, v120
    v_lshl_add_u32 v123, v121, 12, v122
    v_lshl_add_u32 v122, v121, 1, v122
    v_add_u32 v122, v122, v132
    v_add_u32 v123, v123, v135
    v_cmp_gt_u32 vcc, 64, v120
    v_cndmask_b32 v122, v123, v122, vcc
    v_mul_f32 v124, s44, v74
    v_cmp_gt_u32 vcc, 32, v120
    v_cndmask_b32 v124, v74, v124, vcc
    v_cvt_pk_bf16_f32 v124, v124, v124
    v_cmp_gt_u32 vcc, 1728, v118
    v_cndmask_b32 v122, -1, v122, vcc
    buffer_store_short v124, v122, s[28:31], 0 offen
    v_add_u32 v118, 51, v117
    v_mul_u32_u24 v120, s43, v118
    v_lshrrev_b32 v120, 16, v120
    v_mul_u32_u24 v121, 18, v120
    v_sub_u32 v121, v118, v121
    v_lshlrev_b32 v122, 17, v120
    v_lshl_add_u32 v123, v121, 12, v122
    v_lshl_add_u32 v122, v121, 1, v122
    v_add_u32 v122, v122, v132
    v_add_u32 v123, v123, v135
    v_cmp_gt_u32 vcc, 64, v120
    v_cndmask_b32 v122, v123, v122, vcc
    v_mul_f32 v124, s44, v75
    v_cmp_gt_u32 vcc, 32, v120
    v_cndmask_b32 v124, v75, v124, vcc
    v_cvt_pk_bf16_f32 v124, v124, v124
    v_cmp_gt_u32 vcc, 1728, v118
    v_cndmask_b32 v122, -1, v122, vcc
    buffer_store_short v124, v122, s[28:31], 0 offen
    v_add_u32 v118, 56, v117
    v_mul_u32_u24 v120, s43, v118
    v_lshrrev_b32 v120, 16, v120
    v_mul_u32_u24 v121, 18, v120
    v_sub_u32 v121, v118, v121
    v_lshlrev_b32 v122, 17, v120
    v_lshl_add_u32 v123, v121, 12, v122
    v_lshl_add_u32 v122, v121, 1, v122
    v_add_u32 v122, v122, v132
    v_add_u32 v123, v123, v135
    v_cmp_gt_u32 vcc, 64, v120
    v_cndmask_b32 v122, v123, v122, vcc
    v_mul_f32 v124, s44, v76
    v_cmp_gt_u32 vcc, 32, v120
    v_cndmask_b32 v124, v76, v124, vcc
    v_cvt_pk_bf16_f32 v124, v124, v124
    v_cmp_gt_u32 vcc, 1728, v118
    v_cndmask_b32 v122, -1, v122, vcc
    buffer_store_short v124, v122, s[28:31], 0 offen
    v_add_u32 v118, 57, v117
    v_mul_u32_u24 v120, s43, v118
    v_lshrrev_b32 v120, 16, v120
    v_mul_u32_u24 v121, 18, v120
    v_sub_u32 v121, v118, v121
    v_lshlrev_b32 v122, 17, v120
    v_lshl_add_u32 v123, v121, 12, v122
    v_lshl_add_u32 v122, v121, 1, v122
    v_add_u32 v122, v122, v132
    v_add_u32 v123, v123, v135
    v_cmp_gt_u32 vcc, 64, v120
    v_cndmask_b32 v122, v123, v122, vcc
    v_mul_f32 v124, s44, v77
    v_cmp_gt_u32 vcc, 32, v120
    v_cndmask_b32 v124, v77, v124, vcc
    v_cvt_pk_bf16_f32 v124, v124, v124
    v_cmp_gt_u32 vcc, 1728, v118
    v_cndmask_b32 v122, -1, v122, vcc
    buffer_store_short v124, v122, s[28:31], 0 offen
    v_add_u32 v118, 58, v117
    v_mul_u32_u24 v120, s43, v118
    v_lshrrev_b32 v120, 16, v120
    v_mul_u32_u24 v121, 18, v120
    v_sub_u32 v121, v118, v121
    v_lshlrev_b32 v122, 17, v120
    v_lshl_add_u32 v123, v121, 12, v122
    v_lshl_add_u32 v122, v121, 1, v122
    v_add_u32 v122, v122, v132
    v_add_u32 v123, v123, v135
    v_cmp_gt_u32 vcc, 64, v120
    v_cndmask_b32 v122, v123, v122, vcc
    v_mul_f32 v124, s44, v78
    v_cmp_gt_u32 vcc, 32, v120
    v_cndmask_b32 v124, v78, v124, vcc
    v_cvt_pk_bf16_f32 v124, v124, v124
    v_cmp_gt_u32 vcc, 1728, v118
    v_cndmask_b32 v122, -1, v122, vcc
    buffer_store_short v124, v122, s[28:31], 0 offen
    v_add_u32 v118, 59, v117
    v_mul_u32_u24 v120, s43, v118
    v_lshrrev_b32 v120, 16, v120
    v_mul_u32_u24 v121, 18, v120
    v_sub_u32 v121, v118, v121
    v_lshlrev_b32 v122, 17, v120
    v_lshl_add_u32 v123, v121, 12, v122
    v_lshl_add_u32 v122, v121, 1, v122
    v_add_u32 v122, v122, v132
    v_add_u32 v123, v123, v135
    v_cmp_gt_u32 vcc, 64, v120
    v_cndmask_b32 v122, v123, v122, vcc
    v_mul_f32 v124, s44, v79
    v_cmp_gt_u32 vcc, 32, v120
    v_cndmask_b32 v124, v79, v124, vcc
    v_cvt_pk_bf16_f32 v124, v124, v124
    v_cmp_gt_u32 vcc, 1728, v118
    v_cndmask_b32 v122, -1, v122, vcc
    buffer_store_short v124, v122, s[28:31], 0 offen
    v_add_u32 v119, 32, v116
    v_lshlrev_b32 v132, 6, v119
    v_and_b32 v133, 4, v119
    v_and_b32 v134, 8, v119
    v_and_b32 v135, 0xfffffff3, v119
    v_lshl_add_u32 v135, v133, 1, v135
    v_lshrrev_b32 v134, 1, v134
    v_add_u32 v135, v135, v134
    v_lshlrev_b32 v135, 1, v135
    v_add_u32 v118, 0, v117
    v_mul_u32_u24 v120, s43, v118
    v_lshrrev_b32 v120, 16, v120
    v_mul_u32_u24 v121, 18, v120
    v_sub_u32 v121, v118, v121
    v_lshlrev_b32 v122, 17, v120
    v_lshl_add_u32 v123, v121, 12, v122
    v_lshl_add_u32 v122, v121, 1, v122
    v_add_u32 v122, v122, v132
    v_add_u32 v123, v123, v135
    v_cmp_gt_u32 vcc, 64, v120
    v_cndmask_b32 v122, v123, v122, vcc
    v_mul_f32 v124, s44, v80
    v_cmp_gt_u32 vcc, 32, v120
    v_cndmask_b32 v124, v80, v124, vcc
    v_cvt_pk_bf16_f32 v124, v124, v124
    v_cmp_gt_u32 vcc, 1728, v118
    v_cndmask_b32 v122, -1, v122, vcc
    buffer_store_short v124, v122, s[28:31], 0 offen
    v_add_u32 v118, 1, v117
    v_mul_u32_u24 v120, s43, v118
    v_lshrrev_b32 v120, 16, v120
    v_mul_u32_u24 v121, 18, v120
    v_sub_u32 v121, v118, v121
    v_lshlrev_b32 v122, 17, v120
    v_lshl_add_u32 v123, v121, 12, v122
    v_lshl_add_u32 v122, v121, 1, v122
    v_add_u32 v122, v122, v132
    v_add_u32 v123, v123, v135
    v_cmp_gt_u32 vcc, 64, v120
    v_cndmask_b32 v122, v123, v122, vcc
    v_mul_f32 v124, s44, v81
    v_cmp_gt_u32 vcc, 32, v120
    v_cndmask_b32 v124, v81, v124, vcc
    v_cvt_pk_bf16_f32 v124, v124, v124
    v_cmp_gt_u32 vcc, 1728, v118
    v_cndmask_b32 v122, -1, v122, vcc
    buffer_store_short v124, v122, s[28:31], 0 offen
    v_add_u32 v118, 2, v117
    v_mul_u32_u24 v120, s43, v118
    v_lshrrev_b32 v120, 16, v120
    v_mul_u32_u24 v121, 18, v120
    v_sub_u32 v121, v118, v121
    v_lshlrev_b32 v122, 17, v120
    v_lshl_add_u32 v123, v121, 12, v122
    v_lshl_add_u32 v122, v121, 1, v122
    v_add_u32 v122, v122, v132
    v_add_u32 v123, v123, v135
    v_cmp_gt_u32 vcc, 64, v120
    v_cndmask_b32 v122, v123, v122, vcc
    v_mul_f32 v124, s44, v82
    v_cmp_gt_u32 vcc, 32, v120
    v_cndmask_b32 v124, v82, v124, vcc
    v_cvt_pk_bf16_f32 v124, v124, v124
    v_cmp_gt_u32 vcc, 1728, v118
    v_cndmask_b32 v122, -1, v122, vcc
    buffer_store_short v124, v122, s[28:31], 0 offen
    v_add_u32 v118, 3, v117
    v_mul_u32_u24 v120, s43, v118
    v_lshrrev_b32 v120, 16, v120
    v_mul_u32_u24 v121, 18, v120
    v_sub_u32 v121, v118, v121
    v_lshlrev_b32 v122, 17, v120
    v_lshl_add_u32 v123, v121, 12, v122
    v_lshl_add_u32 v122, v121, 1, v122
    v_add_u32 v122, v122, v132
    v_add_u32 v123, v123, v135
    v_cmp_gt_u32 vcc, 64, v120
    v_cndmask_b32 v122, v123, v122, vcc
    v_mul_f32 v124, s44, v83
    v_cmp_gt_u32 vcc, 32, v120
    v_cndmask_b32 v124, v83, v124, vcc
    v_cvt_pk_bf16_f32 v124, v124, v124
    v_cmp_gt_u32 vcc, 1728, v118
    v_cndmask_b32 v122, -1, v122, vcc
    buffer_store_short v124, v122, s[28:31], 0 offen
    v_add_u32 v118, 8, v117
    v_mul_u32_u24 v120, s43, v118
    v_lshrrev_b32 v120, 16, v120
    v_mul_u32_u24 v121, 18, v120
    v_sub_u32 v121, v118, v121
    v_lshlrev_b32 v122, 17, v120
    v_lshl_add_u32 v123, v121, 12, v122
    v_lshl_add_u32 v122, v121, 1, v122
    v_add_u32 v122, v122, v132
    v_add_u32 v123, v123, v135
    v_cmp_gt_u32 vcc, 64, v120
    v_cndmask_b32 v122, v123, v122, vcc
    v_mul_f32 v124, s44, v84
    v_cmp_gt_u32 vcc, 32, v120
    v_cndmask_b32 v124, v84, v124, vcc
    v_cvt_pk_bf16_f32 v124, v124, v124
    v_cmp_gt_u32 vcc, 1728, v118
    v_cndmask_b32 v122, -1, v122, vcc
    buffer_store_short v124, v122, s[28:31], 0 offen
    v_add_u32 v118, 9, v117
    v_mul_u32_u24 v120, s43, v118
    v_lshrrev_b32 v120, 16, v120
    v_mul_u32_u24 v121, 18, v120
    v_sub_u32 v121, v118, v121
    v_lshlrev_b32 v122, 17, v120
    v_lshl_add_u32 v123, v121, 12, v122
    v_lshl_add_u32 v122, v121, 1, v122
    v_add_u32 v122, v122, v132
    v_add_u32 v123, v123, v135
    v_cmp_gt_u32 vcc, 64, v120
    v_cndmask_b32 v122, v123, v122, vcc
    v_mul_f32 v124, s44, v85
    v_cmp_gt_u32 vcc, 32, v120
    v_cndmask_b32 v124, v85, v124, vcc
    v_cvt_pk_bf16_f32 v124, v124, v124
    v_cmp_gt_u32 vcc, 1728, v118
    v_cndmask_b32 v122, -1, v122, vcc
    buffer_store_short v124, v122, s[28:31], 0 offen
    v_add_u32 v118, 10, v117
    v_mul_u32_u24 v120, s43, v118
    v_lshrrev_b32 v120, 16, v120
    v_mul_u32_u24 v121, 18, v120
    v_sub_u32 v121, v118, v121
    v_lshlrev_b32 v122, 17, v120
    v_lshl_add_u32 v123, v121, 12, v122
    v_lshl_add_u32 v122, v121, 1, v122
    v_add_u32 v122, v122, v132
    v_add_u32 v123, v123, v135
    v_cmp_gt_u32 vcc, 64, v120
    v_cndmask_b32 v122, v123, v122, vcc
    v_mul_f32 v124, s44, v86
    v_cmp_gt_u32 vcc, 32, v120
    v_cndmask_b32 v124, v86, v124, vcc
    v_cvt_pk_bf16_f32 v124, v124, v124
    v_cmp_gt_u32 vcc, 1728, v118
    v_cndmask_b32 v122, -1, v122, vcc
    buffer_store_short v124, v122, s[28:31], 0 offen
    v_add_u32 v118, 11, v117
    v_mul_u32_u24 v120, s43, v118
    v_lshrrev_b32 v120, 16, v120
    v_mul_u32_u24 v121, 18, v120
    v_sub_u32 v121, v118, v121
    v_lshlrev_b32 v122, 17, v120
    v_lshl_add_u32 v123, v121, 12, v122
    v_lshl_add_u32 v122, v121, 1, v122
    v_add_u32 v122, v122, v132
    v_add_u32 v123, v123, v135
    v_cmp_gt_u32 vcc, 64, v120
    v_cndmask_b32 v122, v123, v122, vcc
    v_mul_f32 v124, s44, v87
    v_cmp_gt_u32 vcc, 32, v120
    v_cndmask_b32 v124, v87, v124, vcc
    v_cvt_pk_bf16_f32 v124, v124, v124
    v_cmp_gt_u32 vcc, 1728, v118
    v_cndmask_b32 v122, -1, v122, vcc
    buffer_store_short v124, v122, s[28:31], 0 offen
    v_add_u32 v118, 16, v117
    v_mul_u32_u24 v120, s43, v118
    v_lshrrev_b32 v120, 16, v120
    v_mul_u32_u24 v121, 18, v120
    v_sub_u32 v121, v118, v121
    v_lshlrev_b32 v122, 17, v120
    v_lshl_add_u32 v123, v121, 12, v122
    v_lshl_add_u32 v122, v121, 1, v122
    v_add_u32 v122, v122, v132
    v_add_u32 v123, v123, v135
    v_cmp_gt_u32 vcc, 64, v120
    v_cndmask_b32 v122, v123, v122, vcc
    v_mul_f32 v124, s44, v88
    v_cmp_gt_u32 vcc, 32, v120
    v_cndmask_b32 v124, v88, v124, vcc
    v_cvt_pk_bf16_f32 v124, v124, v124
    v_cmp_gt_u32 vcc, 1728, v118
    v_cndmask_b32 v122, -1, v122, vcc
    buffer_store_short v124, v122, s[28:31], 0 offen
    v_add_u32 v118, 17, v117
    v_mul_u32_u24 v120, s43, v118
    v_lshrrev_b32 v120, 16, v120
    v_mul_u32_u24 v121, 18, v120
    v_sub_u32 v121, v118, v121
    v_lshlrev_b32 v122, 17, v120
    v_lshl_add_u32 v123, v121, 12, v122
    v_lshl_add_u32 v122, v121, 1, v122
    v_add_u32 v122, v122, v132
    v_add_u32 v123, v123, v135
    v_cmp_gt_u32 vcc, 64, v120
    v_cndmask_b32 v122, v123, v122, vcc
    v_mul_f32 v124, s44, v89
    v_cmp_gt_u32 vcc, 32, v120
    v_cndmask_b32 v124, v89, v124, vcc
    v_cvt_pk_bf16_f32 v124, v124, v124
    v_cmp_gt_u32 vcc, 1728, v118
    v_cndmask_b32 v122, -1, v122, vcc
    buffer_store_short v124, v122, s[28:31], 0 offen
    v_add_u32 v118, 18, v117
    v_mul_u32_u24 v120, s43, v118
    v_lshrrev_b32 v120, 16, v120
    v_mul_u32_u24 v121, 18, v120
    v_sub_u32 v121, v118, v121
    v_lshlrev_b32 v122, 17, v120
    v_lshl_add_u32 v123, v121, 12, v122
    v_lshl_add_u32 v122, v121, 1, v122
    v_add_u32 v122, v122, v132
    v_add_u32 v123, v123, v135
    v_cmp_gt_u32 vcc, 64, v120
    v_cndmask_b32 v122, v123, v122, vcc
    v_mul_f32 v124, s44, v90
    v_cmp_gt_u32 vcc, 32, v120
    v_cndmask_b32 v124, v90, v124, vcc
    v_cvt_pk_bf16_f32 v124, v124, v124
    v_cmp_gt_u32 vcc, 1728, v118
    v_cndmask_b32 v122, -1, v122, vcc
    buffer_store_short v124, v122, s[28:31], 0 offen
    v_add_u32 v118, 19, v117
    v_mul_u32_u24 v120, s43, v118
    v_lshrrev_b32 v120, 16, v120
    v_mul_u32_u24 v121, 18, v120
    v_sub_u32 v121, v118, v121
    v_lshlrev_b32 v122, 17, v120
    v_lshl_add_u32 v123, v121, 12, v122
    v_lshl_add_u32 v122, v121, 1, v122
    v_add_u32 v122, v122, v132
    v_add_u32 v123, v123, v135
    v_cmp_gt_u32 vcc, 64, v120
    v_cndmask_b32 v122, v123, v122, vcc
    v_mul_f32 v124, s44, v91
    v_cmp_gt_u32 vcc, 32, v120
    v_cndmask_b32 v124, v91, v124, vcc
    v_cvt_pk_bf16_f32 v124, v124, v124
    v_cmp_gt_u32 vcc, 1728, v118
    v_cndmask_b32 v122, -1, v122, vcc
    buffer_store_short v124, v122, s[28:31], 0 offen
    v_add_u32 v118, 24, v117
    v_mul_u32_u24 v120, s43, v118
    v_lshrrev_b32 v120, 16, v120
    v_mul_u32_u24 v121, 18, v120
    v_sub_u32 v121, v118, v121
    v_lshlrev_b32 v122, 17, v120
    v_lshl_add_u32 v123, v121, 12, v122
    v_lshl_add_u32 v122, v121, 1, v122
    v_add_u32 v122, v122, v132
    v_add_u32 v123, v123, v135
    v_cmp_gt_u32 vcc, 64, v120
    v_cndmask_b32 v122, v123, v122, vcc
    v_mul_f32 v124, s44, v92
    v_cmp_gt_u32 vcc, 32, v120
    v_cndmask_b32 v124, v92, v124, vcc
    v_cvt_pk_bf16_f32 v124, v124, v124
    v_cmp_gt_u32 vcc, 1728, v118
    v_cndmask_b32 v122, -1, v122, vcc
    buffer_store_short v124, v122, s[28:31], 0 offen
    v_add_u32 v118, 25, v117
    v_mul_u32_u24 v120, s43, v118
    v_lshrrev_b32 v120, 16, v120
    v_mul_u32_u24 v121, 18, v120
    v_sub_u32 v121, v118, v121
    v_lshlrev_b32 v122, 17, v120
    v_lshl_add_u32 v123, v121, 12, v122
    v_lshl_add_u32 v122, v121, 1, v122
    v_add_u32 v122, v122, v132
    v_add_u32 v123, v123, v135
    v_cmp_gt_u32 vcc, 64, v120
    v_cndmask_b32 v122, v123, v122, vcc
    v_mul_f32 v124, s44, v93
    v_cmp_gt_u32 vcc, 32, v120
    v_cndmask_b32 v124, v93, v124, vcc
    v_cvt_pk_bf16_f32 v124, v124, v124
    v_cmp_gt_u32 vcc, 1728, v118
    v_cndmask_b32 v122, -1, v122, vcc
    buffer_store_short v124, v122, s[28:31], 0 offen
    v_add_u32 v118, 26, v117
    v_mul_u32_u24 v120, s43, v118
    v_lshrrev_b32 v120, 16, v120
    v_mul_u32_u24 v121, 18, v120
    v_sub_u32 v121, v118, v121
    v_lshlrev_b32 v122, 17, v120
    v_lshl_add_u32 v123, v121, 12, v122
    v_lshl_add_u32 v122, v121, 1, v122
    v_add_u32 v122, v122, v132
    v_add_u32 v123, v123, v135
    v_cmp_gt_u32 vcc, 64, v120
    v_cndmask_b32 v122, v123, v122, vcc
    v_mul_f32 v124, s44, v94
    v_cmp_gt_u32 vcc, 32, v120
    v_cndmask_b32 v124, v94, v124, vcc
    v_cvt_pk_bf16_f32 v124, v124, v124
    v_cmp_gt_u32 vcc, 1728, v118
    v_cndmask_b32 v122, -1, v122, vcc
    buffer_store_short v124, v122, s[28:31], 0 offen
    v_add_u32 v118, 27, v117
    v_mul_u32_u24 v120, s43, v118
    v_lshrrev_b32 v120, 16, v120
    v_mul_u32_u24 v121, 18, v120
    v_sub_u32 v121, v118, v121
    v_lshlrev_b32 v122, 17, v120
    v_lshl_add_u32 v123, v121, 12, v122
    v_lshl_add_u32 v122, v121, 1, v122
    v_add_u32 v122, v122, v132
    v_add_u32 v123, v123, v135
    v_cmp_gt_u32 vcc, 64, v120
    v_cndmask_b32 v122, v123, v122, vcc
    v_mul_f32 v124, s44, v95
    v_cmp_gt_u32 vcc, 32, v120
    v_cndmask_b32 v124, v95, v124, vcc
    v_cvt_pk_bf16_f32 v124, v124, v124
    v_cmp_gt_u32 vcc, 1728, v118
    v_cndmask_b32 v122, -1, v122, vcc
    buffer_store_short v124, v122, s[28:31], 0 offen
    v_add_u32 v118, 32, v117
    v_mul_u32_u24 v120, s43, v118
    v_lshrrev_b32 v120, 16, v120
    v_mul_u32_u24 v121, 18, v120
    v_sub_u32 v121, v118, v121
    v_lshlrev_b32 v122, 17, v120
    v_lshl_add_u32 v123, v121, 12, v122
    v_lshl_add_u32 v122, v121, 1, v122
    v_add_u32 v122, v122, v132
    v_add_u32 v123, v123, v135
    v_cmp_gt_u32 vcc, 64, v120
    v_cndmask_b32 v122, v123, v122, vcc
    v_mul_f32 v124, s44, v96
    v_cmp_gt_u32 vcc, 32, v120
    v_cndmask_b32 v124, v96, v124, vcc
    v_cvt_pk_bf16_f32 v124, v124, v124
    v_cmp_gt_u32 vcc, 1728, v118
    v_cndmask_b32 v122, -1, v122, vcc
    buffer_store_short v124, v122, s[28:31], 0 offen
    v_add_u32 v118, 33, v117
    v_mul_u32_u24 v120, s43, v118
    v_lshrrev_b32 v120, 16, v120
    v_mul_u32_u24 v121, 18, v120
    v_sub_u32 v121, v118, v121
    v_lshlrev_b32 v122, 17, v120
    v_lshl_add_u32 v123, v121, 12, v122
    v_lshl_add_u32 v122, v121, 1, v122
    v_add_u32 v122, v122, v132
    v_add_u32 v123, v123, v135
    v_cmp_gt_u32 vcc, 64, v120
    v_cndmask_b32 v122, v123, v122, vcc
    v_mul_f32 v124, s44, v97
    v_cmp_gt_u32 vcc, 32, v120
    v_cndmask_b32 v124, v97, v124, vcc
    v_cvt_pk_bf16_f32 v124, v124, v124
    v_cmp_gt_u32 vcc, 1728, v118
    v_cndmask_b32 v122, -1, v122, vcc
    buffer_store_short v124, v122, s[28:31], 0 offen
    v_add_u32 v118, 34, v117
    v_mul_u32_u24 v120, s43, v118
    v_lshrrev_b32 v120, 16, v120
    v_mul_u32_u24 v121, 18, v120
    v_sub_u32 v121, v118, v121
    v_lshlrev_b32 v122, 17, v120
    v_lshl_add_u32 v123, v121, 12, v122
    v_lshl_add_u32 v122, v121, 1, v122
    v_add_u32 v122, v122, v132
    v_add_u32 v123, v123, v135
    v_cmp_gt_u32 vcc, 64, v120
    v_cndmask_b32 v122, v123, v122, vcc
    v_mul_f32 v124, s44, v98
    v_cmp_gt_u32 vcc, 32, v120
    v_cndmask_b32 v124, v98, v124, vcc
    v_cvt_pk_bf16_f32 v124, v124, v124
    v_cmp_gt_u32 vcc, 1728, v118
    v_cndmask_b32 v122, -1, v122, vcc
    buffer_store_short v124, v122, s[28:31], 0 offen
    v_add_u32 v118, 35, v117
    v_mul_u32_u24 v120, s43, v118
    v_lshrrev_b32 v120, 16, v120
    v_mul_u32_u24 v121, 18, v120
    v_sub_u32 v121, v118, v121
    v_lshlrev_b32 v122, 17, v120
    v_lshl_add_u32 v123, v121, 12, v122
    v_lshl_add_u32 v122, v121, 1, v122
    v_add_u32 v122, v122, v132
    v_add_u32 v123, v123, v135
    v_cmp_gt_u32 vcc, 64, v120
    v_cndmask_b32 v122, v123, v122, vcc
    v_mul_f32 v124, s44, v99
    v_cmp_gt_u32 vcc, 32, v120
    v_cndmask_b32 v124, v99, v124, vcc
    v_cvt_pk_bf16_f32 v124, v124, v124
    v_cmp_gt_u32 vcc, 1728, v118
    v_cndmask_b32 v122, -1, v122, vcc
    buffer_store_short v124, v122, s[28:31], 0 offen
    v_add_u32 v118, 40, v117
    v_mul_u32_u24 v120, s43, v118
    v_lshrrev_b32 v120, 16, v120
    v_mul_u32_u24 v121, 18, v120
    v_sub_u32 v121, v118, v121
    v_lshlrev_b32 v122, 17, v120
    v_lshl_add_u32 v123, v121, 12, v122
    v_lshl_add_u32 v122, v121, 1, v122
    v_add_u32 v122, v122, v132
    v_add_u32 v123, v123, v135
    v_cmp_gt_u32 vcc, 64, v120
    v_cndmask_b32 v122, v123, v122, vcc
    v_mul_f32 v124, s44, v100
    v_cmp_gt_u32 vcc, 32, v120
    v_cndmask_b32 v124, v100, v124, vcc
    v_cvt_pk_bf16_f32 v124, v124, v124
    v_cmp_gt_u32 vcc, 1728, v118
    v_cndmask_b32 v122, -1, v122, vcc
    buffer_store_short v124, v122, s[28:31], 0 offen
    v_add_u32 v118, 41, v117
    v_mul_u32_u24 v120, s43, v118
    v_lshrrev_b32 v120, 16, v120
    v_mul_u32_u24 v121, 18, v120
    v_sub_u32 v121, v118, v121
    v_lshlrev_b32 v122, 17, v120
    v_lshl_add_u32 v123, v121, 12, v122
    v_lshl_add_u32 v122, v121, 1, v122
    v_add_u32 v122, v122, v132
    v_add_u32 v123, v123, v135
    v_cmp_gt_u32 vcc, 64, v120
    v_cndmask_b32 v122, v123, v122, vcc
    v_mul_f32 v124, s44, v101
    v_cmp_gt_u32 vcc, 32, v120
    v_cndmask_b32 v124, v101, v124, vcc
    v_cvt_pk_bf16_f32 v124, v124, v124
    v_cmp_gt_u32 vcc, 1728, v118
    v_cndmask_b32 v122, -1, v122, vcc
    buffer_store_short v124, v122, s[28:31], 0 offen
    v_add_u32 v118, 42, v117
    v_mul_u32_u24 v120, s43, v118
    v_lshrrev_b32 v120, 16, v120
    v_mul_u32_u24 v121, 18, v120
    v_sub_u32 v121, v118, v121
    v_lshlrev_b32 v122, 17, v120
    v_lshl_add_u32 v123, v121, 12, v122
    v_lshl_add_u32 v122, v121, 1, v122
    v_add_u32 v122, v122, v132
    v_add_u32 v123, v123, v135
    v_cmp_gt_u32 vcc, 64, v120
    v_cndmask_b32 v122, v123, v122, vcc
    v_mul_f32 v124, s44, v102
    v_cmp_gt_u32 vcc, 32, v120
    v_cndmask_b32 v124, v102, v124, vcc
    v_cvt_pk_bf16_f32 v124, v124, v124
    v_cmp_gt_u32 vcc, 1728, v118
    v_cndmask_b32 v122, -1, v122, vcc
    buffer_store_short v124, v122, s[28:31], 0 offen
    v_add_u32 v118, 43, v117
    v_mul_u32_u24 v120, s43, v118
    v_lshrrev_b32 v120, 16, v120
    v_mul_u32_u24 v121, 18, v120
    v_sub_u32 v121, v118, v121
    v_lshlrev_b32 v122, 17, v120
    v_lshl_add_u32 v123, v121, 12, v122
    v_lshl_add_u32 v122, v121, 1, v122
    v_add_u32 v122, v122, v132
    v_add_u32 v123, v123, v135
    v_cmp_gt_u32 vcc, 64, v120
    v_cndmask_b32 v122, v123, v122, vcc
    v_mul_f32 v124, s44, v103
    v_cmp_gt_u32 vcc, 32, v120
    v_cndmask_b32 v124, v103, v124, vcc
    v_cvt_pk_bf16_f32 v124, v124, v124
    v_cmp_gt_u32 vcc, 1728, v118
    v_cndmask_b32 v122, -1, v122, vcc
    buffer_store_short v124, v122, s[28:31], 0 offen
    v_add_u32 v118, 48, v117
    v_mul_u32_u24 v120, s43, v118
    v_lshrrev_b32 v120, 16, v120
    v_mul_u32_u24 v121, 18, v120
    v_sub_u32 v121, v118, v121
    v_lshlrev_b32 v122, 17, v120
    v_lshl_add_u32 v123, v121, 12, v122
    v_lshl_add_u32 v122, v121, 1, v122
    v_add_u32 v122, v122, v132
    v_add_u32 v123, v123, v135
    v_cmp_gt_u32 vcc, 64, v120
    v_cndmask_b32 v122, v123, v122, vcc
    v_mul_f32 v124, s44, v104
    v_cmp_gt_u32 vcc, 32, v120
    v_cndmask_b32 v124, v104, v124, vcc
    v_cvt_pk_bf16_f32 v124, v124, v124
    v_cmp_gt_u32 vcc, 1728, v118
    v_cndmask_b32 v122, -1, v122, vcc
    buffer_store_short v124, v122, s[28:31], 0 offen
    v_add_u32 v118, 49, v117
    v_mul_u32_u24 v120, s43, v118
    v_lshrrev_b32 v120, 16, v120
    v_mul_u32_u24 v121, 18, v120
    v_sub_u32 v121, v118, v121
    v_lshlrev_b32 v122, 17, v120
    v_lshl_add_u32 v123, v121, 12, v122
    v_lshl_add_u32 v122, v121, 1, v122
    v_add_u32 v122, v122, v132
    v_add_u32 v123, v123, v135
    v_cmp_gt_u32 vcc, 64, v120
    v_cndmask_b32 v122, v123, v122, vcc
    v_mul_f32 v124, s44, v105
    v_cmp_gt_u32 vcc, 32, v120
    v_cndmask_b32 v124, v105, v124, vcc
    v_cvt_pk_bf16_f32 v124, v124, v124
    v_cmp_gt_u32 vcc, 1728, v118
    v_cndmask_b32 v122, -1, v122, vcc
    buffer_store_short v124, v122, s[28:31], 0 offen
    v_add_u32 v118, 50, v117
    v_mul_u32_u24 v120, s43, v118
    v_lshrrev_b32 v120, 16, v120
    v_mul_u32_u24 v121, 18, v120
    v_sub_u32 v121, v118, v121
    v_lshlrev_b32 v122, 17, v120
    v_lshl_add_u32 v123, v121, 12, v122
    v_lshl_add_u32 v122, v121, 1, v122
    v_add_u32 v122, v122, v132
    v_add_u32 v123, v123, v135
    v_cmp_gt_u32 vcc, 64, v120
    v_cndmask_b32 v122, v123, v122, vcc
    v_mul_f32 v124, s44, v106
    v_cmp_gt_u32 vcc, 32, v120
    v_cndmask_b32 v124, v106, v124, vcc
    v_cvt_pk_bf16_f32 v124, v124, v124
    v_cmp_gt_u32 vcc, 1728, v118
    v_cndmask_b32 v122, -1, v122, vcc
    buffer_store_short v124, v122, s[28:31], 0 offen
    v_add_u32 v118, 51, v117
    v_mul_u32_u24 v120, s43, v118
    v_lshrrev_b32 v120, 16, v120
    v_mul_u32_u24 v121, 18, v120
    v_sub_u32 v121, v118, v121
    v_lshlrev_b32 v122, 17, v120
    v_lshl_add_u32 v123, v121, 12, v122
    v_lshl_add_u32 v122, v121, 1, v122
    v_add_u32 v122, v122, v132
    v_add_u32 v123, v123, v135
    v_cmp_gt_u32 vcc, 64, v120
    v_cndmask_b32 v122, v123, v122, vcc
    v_mul_f32 v124, s44, v107
    v_cmp_gt_u32 vcc, 32, v120
    v_cndmask_b32 v124, v107, v124, vcc
    v_cvt_pk_bf16_f32 v124, v124, v124
    v_cmp_gt_u32 vcc, 1728, v118
    v_cndmask_b32 v122, -1, v122, vcc
    buffer_store_short v124, v122, s[28:31], 0 offen
    v_add_u32 v118, 56, v117
    v_mul_u32_u24 v120, s43, v118
    v_lshrrev_b32 v120, 16, v120
    v_mul_u32_u24 v121, 18, v120
    v_sub_u32 v121, v118, v121
    v_lshlrev_b32 v122, 17, v120
    v_lshl_add_u32 v123, v121, 12, v122
    v_lshl_add_u32 v122, v121, 1, v122
    v_add_u32 v122, v122, v132
    v_add_u32 v123, v123, v135
    v_cmp_gt_u32 vcc, 64, v120
    v_cndmask_b32 v122, v123, v122, vcc
    v_mul_f32 v124, s44, v108
    v_cmp_gt_u32 vcc, 32, v120
    v_cndmask_b32 v124, v108, v124, vcc
    v_cvt_pk_bf16_f32 v124, v124, v124
    v_cmp_gt_u32 vcc, 1728, v118
    v_cndmask_b32 v122, -1, v122, vcc
    buffer_store_short v124, v122, s[28:31], 0 offen
    v_add_u32 v118, 57, v117
    v_mul_u32_u24 v120, s43, v118
    v_lshrrev_b32 v120, 16, v120
    v_mul_u32_u24 v121, 18, v120
    v_sub_u32 v121, v118, v121
    v_lshlrev_b32 v122, 17, v120
    v_lshl_add_u32 v123, v121, 12, v122
    v_lshl_add_u32 v122, v121, 1, v122
    v_add_u32 v122, v122, v132
    v_add_u32 v123, v123, v135
    v_cmp_gt_u32 vcc, 64, v120
    v_cndmask_b32 v122, v123, v122, vcc
    v_mul_f32 v124, s44, v109
    v_cmp_gt_u32 vcc, 32, v120
    v_cndmask_b32 v124, v109, v124, vcc
    v_cvt_pk_bf16_f32 v124, v124, v124
    v_cmp_gt_u32 vcc, 1728, v118
    v_cndmask_b32 v122, -1, v122, vcc
    buffer_store_short v124, v122, s[28:31], 0 offen
    v_add_u32 v118, 58, v117
    v_mul_u32_u24 v120, s43, v118
    v_lshrrev_b32 v120, 16, v120
    v_mul_u32_u24 v121, 18, v120
    v_sub_u32 v121, v118, v121
    v_lshlrev_b32 v122, 17, v120
    v_lshl_add_u32 v123, v121, 12, v122
    v_lshl_add_u32 v122, v121, 1, v122
    v_add_u32 v122, v122, v132
    v_add_u32 v123, v123, v135
    v_cmp_gt_u32 vcc, 64, v120
    v_cndmask_b32 v122, v123, v122, vcc
    v_mul_f32 v124, s44, v110
    v_cmp_gt_u32 vcc, 32, v120
    v_cndmask_b32 v124, v110, v124, vcc
    v_cvt_pk_bf16_f32 v124, v124, v124
    v_cmp_gt_u32 vcc, 1728, v118
    v_cndmask_b32 v122, -1, v122, vcc
    buffer_store_short v124, v122, s[28:31], 0 offen
    v_add_u32 v118, 59, v117
    v_mul_u32_u24 v120, s43, v118
    v_lshrrev_b32 v120, 16, v120
    v_mul_u32_u24 v121, 18, v120
    v_sub_u32 v121, v118, v121
    v_lshlrev_b32 v122, 17, v120
    v_lshl_add_u32 v123, v121, 12, v122
    v_lshl_add_u32 v122, v121, 1, v122
    v_add_u32 v122, v122, v132
    v_add_u32 v123, v123, v135
    v_cmp_gt_u32 vcc, 64, v120
    v_cndmask_b32 v122, v123, v122, vcc
    v_mul_f32 v124, s44, v111
    v_cmp_gt_u32 vcc, 32, v120
    v_cndmask_b32 v124, v111, v124, vcc
    v_cvt_pk_bf16_f32 v124, v124, v124
    v_cmp_gt_u32 vcc, 1728, v118
    v_cndmask_b32 v122, -1, v122, vcc
    buffer_store_short v124, v122, s[28:31], 0 offen
qkv_kernel_done:
    s_endpgm

.globl attn_kernel
.p2align 8
.type attn_kernel,@function
attn_kernel:
    s_cmp_ge_u32 s2, 256
    s_cbranch_scc1 attn_kernel_done
    s_load_dwordx2 s[8:9], s[0:1], 88
    s_waitcnt lgkmcnt(0)

    s_add_u32 s12, s8, 4194304
    s_addc_u32 s13, s9, 0
    s_mov_b32 s14, 4194304
    s_mov_b32 s15, 0x00020000
    s_add_u32 s16, s8, 8388608
    s_addc_u32 s17, s9, 0
    s_mov_b32 s18, 4194304
    s_mov_b32 s19, 0x00020000
    s_add_u32 s20, s8, 12582912
    s_addc_u32 s21, s9, 0
    s_mov_b32 s22, 4194304
    s_mov_b32 s23, 0x00020000
    s_add_u32 s24, s8, 16777216
    s_addc_u32 s25, s9, 0
    s_mov_b32 s26, 2359296
    s_mov_b32 s27, 0x00020000
    s_and_b32 s29, s2, 7
    s_lshl_b32 s29, s29, 5
    s_lshr_b32 s30, s2, 3
    s_add_u32 s29, s29, s30
    s_lshr_b32 s30, s29, 3
    s_and_b32 s31, s29, 7
    s_lshl_b32 s32, s30, 17
    s_lshl_b32 s33, s31, 14
    s_add_u32 s33, s33, s32
    v_and_b32 v1, 63, v0
    v_lshrrev_b32 v2, 6, v0
    v_and_b32 v3, 31, v1
    v_lshrrev_b32 v4, 5, v1
    v_readfirstlane_b32 s45, v2
    v_lshl_add_u32 v5, v2, 5, v3
    v_lshlrev_b32 v5, 6, v5
    v_lshl_add_u32 v5, v4, 4, v5
    v_add_u32 v5, s33, v5
    buffer_load_dwordx4 v[16:19], v5, s[12:15], 0 offen
    buffer_load_dwordx4 v[20:23], v5, s[12:15], 0 offen offset:32
    s_lshl_b32 s46, s45, 10

    v_lshrrev_b32 v6, 2, v1
    v_lshl_add_u32 v6, v2, 4, v6
    v_lshlrev_b32 v6, 6, v6
    v_and_b32 v7, 3, v1
    v_lshrrev_b32 v8, 4, v1
    v_xor_b32 v7, v7, v8
    v_lshl_add_u32 v6, v7, 4, v6
    v_add_u32 v6, s32, v6
    v_lshl_add_u32 v9, v2, 2, v8
    v_and_b32 v10, 15, v1
    v_and_b32 v11, 15, v9
    v_xor_b32 v10, v10, v11
    v_lshlrev_b32 v11, 12, v9
    v_lshl_add_u32 v11, v10, 4, v11
    v_add_u32 v11, s32, v11

    v_lshrrev_b32 v7, 2, v3
    v_and_b32 v7, 3, v7
    v_xor_b32 v7, v7, v4
    v_lshlrev_b32 v12, 6, v3
    v_lshl_add_u32 v13, v7, 4, v12
    v_xor_b32 v7, 2, v7
    v_lshl_add_u32 v14, v7, 4, v12
    v_mov_b32 v12, v13
    v_and_b32 v7, 15, v3
    v_mov_b32 v15, 0xff800000

    v_add_u32 v8, 0, v4
    v_xor_b32 v8, v8, v7
    v_lshlrev_b32 v88, 8, v3
    v_lshl_add_u32 v88, v8, 4, v88
    v_add_u32 v88, 8192, v88
    v_add_u32 v8, 2, v4
    v_xor_b32 v8, v8, v7
    v_lshlrev_b32 v89, 8, v3
    v_lshl_add_u32 v89, v8, 4, v89
    v_add_u32 v89, 8192, v89
    v_add_u32 v8, 4, v4
    v_xor_b32 v8, v8, v7
    v_lshlrev_b32 v90, 8, v3
    v_lshl_add_u32 v90, v8, 4, v90
    v_add_u32 v90, 8192, v90
    v_add_u32 v8, 6, v4
    v_xor_b32 v8, v8, v7
    v_lshlrev_b32 v91, 8, v3
    v_lshl_add_u32 v91, v8, 4, v91
    v_add_u32 v91, 8192, v91
    v_add_u32 v8, 8, v4
    v_xor_b32 v8, v8, v7
    v_lshlrev_b32 v92, 8, v3
    v_lshl_add_u32 v92, v8, 4, v92
    v_add_u32 v92, 8192, v92
    v_add_u32 v8, 10, v4
    v_xor_b32 v8, v8, v7
    v_lshlrev_b32 v93, 8, v3
    v_lshl_add_u32 v93, v8, 4, v93
    v_add_u32 v93, 8192, v93
    v_add_u32 v8, 12, v4
    v_xor_b32 v8, v8, v7
    v_lshlrev_b32 v94, 8, v3
    v_lshl_add_u32 v94, v8, 4, v94
    v_add_u32 v94, 8192, v94
    v_add_u32 v8, 14, v4
    v_xor_b32 v8, v8, v7
    v_lshlrev_b32 v95, 8, v3
    v_lshl_add_u32 v95, v8, 4, v95
    v_add_u32 v95, 8192, v95
    s_mov_b32 s40, 0
    s_waitcnt vmcnt(0)
    s_add_u32 m0, s46, 0
    s_nop 0
    buffer_load_dwordx4 v6, s[16:19], s40 offen lds
    s_add_u32 s40, s40, 8192
    s_add_u32 m0, s46, 16384
    s_nop 0
    buffer_load_dwordx4 v6, s[16:19], s40 offen lds
    s_add_u32 s40, s40, 8192
    s_add_u32 m0, s46, 32768
    s_nop 0
    buffer_load_dwordx4 v6, s[16:19], s40 offen lds
    s_add_u32 s40, s40, 8192
    s_mov_b32 s42, 4
attn_p1:
    s_waitcnt vmcnt(2)
    s_barrier
    ds_read_b128 v[24:27], v12 offset:0
    ds_read_b128 v[28:31], v14 offset:0
    s_add_u32 m0, s46, 49152
    s_nop 0
    buffer_load_dwordx4 v6, s[16:19], s40 offen lds
    s_add_u32 s40, s40, 8192
    s_waitcnt lgkmcnt(0)
    v_mfma_f32_32x32x16_bf16 v[40:55], v[24:27], v[16:19], 0
    v_mfma_f32_32x32x16_bf16 v[40:55], v[28:31], v[20:23], v[40:55]
    ds_read_b128 v[24:27], v12 offset:2048
    ds_read_b128 v[28:31], v14 offset:2048
    s_waitcnt lgkmcnt(0)
    v_mfma_f32_32x32x16_bf16 v[56:71], v[24:27], v[16:19], 0
    v_mfma_f32_32x32x16_bf16 v[56:71], v[28:31], v[20:23], v[56:71]
    s_nop 9
    v_max3_f32 v15, v15, v40, v41
    v_max3_f32 v15, v15, v42, v43
    v_max3_f32 v15, v15, v44, v45
    v_max3_f32 v15, v15, v46, v47
    v_max3_f32 v15, v15, v48, v49
    v_max3_f32 v15, v15, v50, v51
    v_max3_f32 v15, v15, v52, v53
    v_max3_f32 v15, v15, v54, v55
    ds_read_b128 v[24:27], v12 offset:4096
    ds_read_b128 v[28:31], v14 offset:4096
    s_waitcnt lgkmcnt(0)
    v_mfma_f32_32x32x16_bf16 v[40:55], v[24:27], v[16:19], 0
    v_mfma_f32_32x32x16_bf16 v[40:55], v[28:31], v[20:23], v[40:55]
    s_nop 9
    v_max3_f32 v15, v15, v56, v57
    v_max3_f32 v15, v15, v58, v59
    v_max3_f32 v15, v15, v60, v61
    v_max3_f32 v15, v15, v62, v63
    v_max3_f32 v15, v15, v64, v65
    v_max3_f32 v15, v15, v66, v67
    v_max3_f32 v15, v15, v68, v69
    v_max3_f32 v15, v15, v70, v71
    ds_read_b128 v[24:27], v12 offset:6144
    ds_read_b128 v[28:31], v14 offset:6144
    s_waitcnt lgkmcnt(0)
    v_mfma_f32_32x32x16_bf16 v[56:71], v[24:27], v[16:19], 0
    v_mfma_f32_32x32x16_bf16 v[56:71], v[28:31], v[20:23], v[56:71]
    s_nop 9
    v_max3_f32 v15, v15, v40, v41
    v_max3_f32 v15, v15, v42, v43
    v_max3_f32 v15, v15, v44, v45
    v_max3_f32 v15, v15, v46, v47
    v_max3_f32 v15, v15, v48, v49
    v_max3_f32 v15, v15, v50, v51
    v_max3_f32 v15, v15, v52, v53
    v_max3_f32 v15, v15, v54, v55
    s_nop 15
    v_max3_f32 v15, v15, v56, v57
    v_max3_f32 v15, v15, v58, v59
    v_max3_f32 v15, v15, v60, v61
    v_max3_f32 v15, v15, v62, v63
    v_max3_f32 v15, v15, v64, v65
    v_max3_f32 v15, v15, v66, v67
    v_max3_f32 v15, v15, v68, v69
    v_max3_f32 v15, v15, v70, v71
    s_waitcnt vmcnt(2)
    s_barrier
    ds_read_b128 v[24:27], v12 offset:16384
    ds_read_b128 v[28:31], v14 offset:16384
    s_add_u32 m0, s46, 0
    s_nop 0
    buffer_load_dwordx4 v6, s[16:19], s40 offen lds
    s_add_u32 s40, s40, 8192
    s_waitcnt lgkmcnt(0)
    v_mfma_f32_32x32x16_bf16 v[40:55], v[24:27], v[16:19], 0
    v_mfma_f32_32x32x16_bf16 v[40:55], v[28:31], v[20:23], v[40:55]
    ds_read_b128 v[24:27], v12 offset:18432
    ds_read_b128 v[28:31], v14 offset:18432
    s_waitcnt lgkmcnt(0)
    v_mfma_f32_32x32x16_bf16 v[56:71], v[24:27], v[16:19], 0
    v_mfma_f32_32x32x16_bf16 v[56:71], v[28:31], v[20:23], v[56:71]
    s_nop 9
    v_max3_f32 v15, v15, v40, v41
    v_max3_f32 v15, v15, v42, v43
    v_max3_f32 v15, v15, v44, v45
    v_max3_f32 v15, v15, v46, v47
    v_max3_f32 v15, v15, v48, v49
    v_max3_f32 v15, v15, v50, v51
    v_max3_f32 v15, v15, v52, v53
    v_max3_f32 v15, v15, v54, v55
    ds_read_b128 v[24:27], v12 offset:20480
    ds_read_b128 v[28:31], v14 offset:20480
    s_waitcnt lgkmcnt(0)
    v_mfma_f32_32x32x16_bf16 v[40:55], v[24:27], v[16:19], 0
    v_mfma_f32_32x32x16_bf16 v[40:55], v[28:31], v[20:23], v[40:55]
    s_nop 9
    v_max3_f32 v15, v15, v56, v57
    v_max3_f32 v15, v15, v58, v59
    v_max3_f32 v15, v15, v60, v61
    v_max3_f32 v15, v15, v62, v63
    v_max3_f32 v15, v15, v64, v65
    v_max3_f32 v15, v15, v66, v67
    v_max3_f32 v15, v15, v68, v69
    v_max3_f32 v15, v15, v70, v71
    ds_read_b128 v[24:27], v12 offset:22528
    ds_read_b128 v[28:31], v14 offset:22528
    s_waitcnt lgkmcnt(0)
    v_mfma_f32_32x32x16_bf16 v[56:71], v[24:27], v[16:19], 0
    v_mfma_f32_32x32x16_bf16 v[56:71], v[28:31], v[20:23], v[56:71]
    s_nop 9
    v_max3_f32 v15, v15, v40, v41
    v_max3_f32 v15, v15, v42, v43
    v_max3_f32 v15, v15, v44, v45
    v_max3_f32 v15, v15, v46, v47
    v_max3_f32 v15, v15, v48, v49
    v_max3_f32 v15, v15, v50, v51
    v_max3_f32 v15, v15, v52, v53
    v_max3_f32 v15, v15, v54, v55
    s_nop 15
    v_max3_f32 v15, v15, v56, v57
    v_max3_f32 v15, v15, v58, v59
    v_max3_f32 v15, v15, v60, v61
    v_max3_f32 v15, v15, v62, v63
    v_max3_f32 v15, v15, v64, v65
    v_max3_f32 v15, v15, v66, v67
    v_max3_f32 v15, v15, v68, v69
    v_max3_f32 v15, v15, v70, v71
    s_waitcnt vmcnt(2)
    s_barrier
    ds_read_b128 v[24:27], v12 offset:32768
    ds_read_b128 v[28:31], v14 offset:32768
    s_add_u32 m0, s46, 16384
    s_nop 0
    buffer_load_dwordx4 v6, s[16:19], s40 offen lds
    s_add_u32 s40, s40, 8192
    s_waitcnt lgkmcnt(0)
    v_mfma_f32_32x32x16_bf16 v[40:55], v[24:27], v[16:19], 0
    v_mfma_f32_32x32x16_bf16 v[40:55], v[28:31], v[20:23], v[40:55]
    ds_read_b128 v[24:27], v12 offset:34816
    ds_read_b128 v[28:31], v14 offset:34816
    s_waitcnt lgkmcnt(0)
    v_mfma_f32_32x32x16_bf16 v[56:71], v[24:27], v[16:19], 0
    v_mfma_f32_32x32x16_bf16 v[56:71], v[28:31], v[20:23], v[56:71]
    s_nop 9
    v_max3_f32 v15, v15, v40, v41
    v_max3_f32 v15, v15, v42, v43
    v_max3_f32 v15, v15, v44, v45
    v_max3_f32 v15, v15, v46, v47
    v_max3_f32 v15, v15, v48, v49
    v_max3_f32 v15, v15, v50, v51
    v_max3_f32 v15, v15, v52, v53
    v_max3_f32 v15, v15, v54, v55
    ds_read_b128 v[24:27], v12 offset:36864
    ds_read_b128 v[28:31], v14 offset:36864
    s_waitcnt lgkmcnt(0)
    v_mfma_f32_32x32x16_bf16 v[40:55], v[24:27], v[16:19], 0
    v_mfma_f32_32x32x16_bf16 v[40:55], v[28:31], v[20:23], v[40:55]
    s_nop 9
    v_max3_f32 v15, v15, v56, v57
    v_max3_f32 v15, v15, v58, v59
    v_max3_f32 v15, v15, v60, v61
    v_max3_f32 v15, v15, v62, v63
    v_max3_f32 v15, v15, v64, v65
    v_max3_f32 v15, v15, v66, v67
    v_max3_f32 v15, v15, v68, v69
    v_max3_f32 v15, v15, v70, v71
    ds_read_b128 v[24:27], v12 offset:38912
    ds_read_b128 v[28:31], v14 offset:38912
    s_waitcnt lgkmcnt(0)
    v_mfma_f32_32x32x16_bf16 v[56:71], v[24:27], v[16:19], 0
    v_mfma_f32_32x32x16_bf16 v[56:71], v[28:31], v[20:23], v[56:71]
    s_nop 9
    v_max3_f32 v15, v15, v40, v41
    v_max3_f32 v15, v15, v42, v43
    v_max3_f32 v15, v15, v44, v45
    v_max3_f32 v15, v15, v46, v47
    v_max3_f32 v15, v15, v48, v49
    v_max3_f32 v15, v15, v50, v51
    v_max3_f32 v15, v15, v52, v53
    v_max3_f32 v15, v15, v54, v55
    s_nop 15
    v_max3_f32 v15, v15, v56, v57
    v_max3_f32 v15, v15, v58, v59
    v_max3_f32 v15, v15, v60, v61
    v_max3_f32 v15, v15, v62, v63
    v_max3_f32 v15, v15, v64, v65
    v_max3_f32 v15, v15, v66, v67
    v_max3_f32 v15, v15, v68, v69
    v_max3_f32 v15, v15, v70, v71
    s_waitcnt vmcnt(2)
    s_barrier
    ds_read_b128 v[24:27], v12 offset:49152
    ds_read_b128 v[28:31], v14 offset:49152
    s_add_u32 m0, s46, 32768
    s_nop 0
    buffer_load_dwordx4 v6, s[16:19], s40 offen lds
    s_add_u32 s40, s40, 8192
    s_waitcnt lgkmcnt(0)
    v_mfma_f32_32x32x16_bf16 v[40:55], v[24:27], v[16:19], 0
    v_mfma_f32_32x32x16_bf16 v[40:55], v[28:31], v[20:23], v[40:55]
    ds_read_b128 v[24:27], v12 offset:51200
    ds_read_b128 v[28:31], v14 offset:51200
    s_waitcnt lgkmcnt(0)
    v_mfma_f32_32x32x16_bf16 v[56:71], v[24:27], v[16:19], 0
    v_mfma_f32_32x32x16_bf16 v[56:71], v[28:31], v[20:23], v[56:71]
    s_nop 9
    v_max3_f32 v15, v15, v40, v41
    v_max3_f32 v15, v15, v42, v43
    v_max3_f32 v15, v15, v44, v45
    v_max3_f32 v15, v15, v46, v47
    v_max3_f32 v15, v15, v48, v49
    v_max3_f32 v15, v15, v50, v51
    v_max3_f32 v15, v15, v52, v53
    v_max3_f32 v15, v15, v54, v55
    ds_read_b128 v[24:27], v12 offset:53248
    ds_read_b128 v[28:31], v14 offset:53248
    s_waitcnt lgkmcnt(0)
    v_mfma_f32_32x32x16_bf16 v[40:55], v[24:27], v[16:19], 0
    v_mfma_f32_32x32x16_bf16 v[40:55], v[28:31], v[20:23], v[40:55]
    s_nop 9
    v_max3_f32 v15, v15, v56, v57
    v_max3_f32 v15, v15, v58, v59
    v_max3_f32 v15, v15, v60, v61
    v_max3_f32 v15, v15, v62, v63
    v_max3_f32 v15, v15, v64, v65
    v_max3_f32 v15, v15, v66, v67
    v_max3_f32 v15, v15, v68, v69
    v_max3_f32 v15, v15, v70, v71
    ds_read_b128 v[24:27], v12 offset:55296
    ds_read_b128 v[28:31], v14 offset:55296
    s_waitcnt lgkmcnt(0)
    v_mfma_f32_32x32x16_bf16 v[56:71], v[24:27], v[16:19], 0
    v_mfma_f32_32x32x16_bf16 v[56:71], v[28:31], v[20:23], v[56:71]
    s_nop 9
    v_max3_f32 v15, v15, v40, v41
    v_max3_f32 v15, v15, v42, v43
    v_max3_f32 v15, v15, v44, v45
    v_max3_f32 v15, v15, v46, v47
    v_max3_f32 v15, v15, v48, v49
    v_max3_f32 v15, v15, v50, v51
    v_max3_f32 v15, v15, v52, v53
    v_max3_f32 v15, v15, v54, v55
    s_nop 15
    v_max3_f32 v15, v15, v56, v57
    v_max3_f32 v15, v15, v58, v59
    v_max3_f32 v15, v15, v60, v61
    v_max3_f32 v15, v15, v62, v63
    v_max3_f32 v15, v15, v64, v65
    v_max3_f32 v15, v15, v66, v67
    v_max3_f32 v15, v15, v68, v69
    v_max3_f32 v15, v15, v70, v71
    s_sub_u32 s42, s42, 1
    s_cmp_lg_u32 s42, 0
    s_cbranch_scc1 attn_p1
    s_waitcnt vmcnt(0)
    v_mov_b32 v48, v15
    s_nop 1
    v_permlane32_swap_b32 v48, v15
    v_max_f32 v15, v15, v48

    v_cvt_pk_bf16_f32 v49, v15, v15
    v_lshlrev_b32 v50, 16, v49
    v_sub_f32 v50, v15, v50
    v_cvt_pk_bf16_f32 v50, v50, v50
    v_and_b32 v49, 0xffff, v49
    v_lshl_or_b32 v49, v50, 16, v49
    v_xor_b32 v49, 0x80008000, v49
    v_cmp_gt_u32 vcc, 32, v1
    v_cndmask_b32 v21, v21, v49, vcc
    s_barrier

    v_mov_b32 v96, 0
    v_mov_b32 v97, 0
    v_mov_b32 v98, 0
    v_mov_b32 v99, 0
    v_mov_b32 v100, 0
    v_mov_b32 v101, 0
    v_mov_b32 v102, 0
    v_mov_b32 v103, 0
    v_mov_b32 v104, 0
    v_mov_b32 v105, 0
    v_mov_b32 v106, 0
    v_mov_b32 v107, 0
    v_mov_b32 v108, 0
    v_mov_b32 v109, 0
    v_mov_b32 v110, 0
    v_mov_b32 v111, 0
    s_mov_b32 s40, 0
    s_mov_b32 s41, 0
    s_add_u32 m0, s46, 0
    s_nop 0
    buffer_load_dwordx4 v6, s[16:19], s40 offen lds
    s_add_u32 s40, s40, 8192
    s_add_u32 m0, s46, 8192
    s_nop 0
    buffer_load_dwordx4 v11, s[20:23], s41 offen lds
    s_add_u32 s41, s41, 256
    s_add_u32 m0, s46, 16384
    s_nop 0
    buffer_load_dwordx4 v6, s[16:19], s40 offen lds
    s_add_u32 s40, s40, 8192
    s_add_u32 m0, s46, 24576
    s_nop 0
    buffer_load_dwordx4 v11, s[20:23], s41 offen lds
    s_add_u32 s41, s41, 256
    s_add_u32 m0, s46, 32768
    s_nop 0
    buffer_load_dwordx4 v6, s[16:19], s40 offen lds
    s_add_u32 s40, s40, 8192
    s_add_u32 m0, s46, 40960
    s_nop 0
    buffer_load_dwordx4 v11, s[20:23], s41 offen lds
    s_add_u32 s41, s41, 256
    s_mov_b32 s42, 4
attn_p2:
    s_waitcnt vmcnt(4)
    s_barrier
    ds_read_b128 v[24:27], v12 offset:0
    ds_read_b128 v[28:31], v14 offset:0
    s_add_u32 m0, s46, 49152
    s_nop 0
    buffer_load_dwordx4 v6, s[16:19], s40 offen lds
    s_add_u32 s40, s40, 8192
    s_add_u32 m0, s46, 57344
    s_nop 0
    buffer_load_dwordx4 v11, s[20:23], s41 offen lds
    s_add_u32 s41, s41, 256
    s_waitcnt lgkmcnt(0)
    v_mfma_f32_32x32x16_bf16 v[40:55], v[24:27], v[16:19], 0
    v_mfma_f32_32x32x16_bf16 v[40:55], v[28:31], v[20:23], v[40:55]
    ds_read_b128 v[24:27], v12 offset:2048
    ds_read_b128 v[28:31], v14 offset:2048
    ds_read_b128 v[32:35], v88 offset:0
    ds_read_b128 v[36:39], v89 offset:0
    s_nop 9
    s_waitcnt lgkmcnt(2)
    v_mfma_f32_32x32x16_bf16 v[56:71], v[24:27], v[16:19], 0
    v_exp_f32 v40, v40
    v_exp_f32 v41, v41
    v_exp_f32 v42, v42
    v_exp_f32 v43, v43
    v_exp_f32 v44, v44
    v_exp_f32 v45, v45
    v_exp_f32 v46, v46
    v_exp_f32 v47, v47
    v_mfma_f32_32x32x16_bf16 v[56:71], v[28:31], v[20:23], v[56:71]
    v_exp_f32 v48, v48
    v_exp_f32 v49, v49
    v_exp_f32 v50, v50
    v_exp_f32 v51, v51
    v_exp_f32 v52, v52
    v_exp_f32 v53, v53
    v_exp_f32 v54, v54
    v_exp_f32 v55, v55
    v_cvt_pk_bf16_f32 v72, v40, v41
    v_cvt_pk_bf16_f32 v73, v42, v43
    v_cvt_pk_bf16_f32 v74, v44, v45
    v_cvt_pk_bf16_f32 v75, v46, v47
    v_cvt_pk_bf16_f32 v76, v48, v49
    v_cvt_pk_bf16_f32 v77, v50, v51
    v_cvt_pk_bf16_f32 v78, v52, v53
    v_cvt_pk_bf16_f32 v79, v54, v55
    s_waitcnt lgkmcnt(0)
    v_mfma_f32_32x32x16_bf16 v[96:111], v[32:35], v[72:75], v[96:111]
    v_mfma_f32_32x32x16_bf16 v[96:111], v[36:39], v[76:79], v[96:111]
    ds_read_b128 v[24:27], v12 offset:4096
    ds_read_b128 v[28:31], v14 offset:4096
    ds_read_b128 v[32:35], v90 offset:0
    ds_read_b128 v[36:39], v91 offset:0
    s_waitcnt lgkmcnt(2)
    v_mfma_f32_32x32x16_bf16 v[40:55], v[24:27], v[16:19], 0
    v_exp_f32 v56, v56
    v_exp_f32 v57, v57
    v_exp_f32 v58, v58
    v_exp_f32 v59, v59
    v_exp_f32 v60, v60
    v_exp_f32 v61, v61
    v_exp_f32 v62, v62
    v_exp_f32 v63, v63
    v_mfma_f32_32x32x16_bf16 v[40:55], v[28:31], v[20:23], v[40:55]
    v_exp_f32 v64, v64
    v_exp_f32 v65, v65
    v_exp_f32 v66, v66
    v_exp_f32 v67, v67
    v_exp_f32 v68, v68
    v_exp_f32 v69, v69
    v_exp_f32 v70, v70
    v_exp_f32 v71, v71
    v_cvt_pk_bf16_f32 v72, v56, v57
    v_cvt_pk_bf16_f32 v73, v58, v59
    v_cvt_pk_bf16_f32 v74, v60, v61
    v_cvt_pk_bf16_f32 v75, v62, v63
    v_cvt_pk_bf16_f32 v76, v64, v65
    v_cvt_pk_bf16_f32 v77, v66, v67
    v_cvt_pk_bf16_f32 v78, v68, v69
    v_cvt_pk_bf16_f32 v79, v70, v71
    s_waitcnt lgkmcnt(0)
    v_mfma_f32_32x32x16_bf16 v[96:111], v[32:35], v[72:75], v[96:111]
    v_mfma_f32_32x32x16_bf16 v[96:111], v[36:39], v[76:79], v[96:111]
    ds_read_b128 v[24:27], v12 offset:6144
    ds_read_b128 v[28:31], v14 offset:6144
    ds_read_b128 v[32:35], v92 offset:0
    ds_read_b128 v[36:39], v93 offset:0
    s_waitcnt lgkmcnt(2)
    v_mfma_f32_32x32x16_bf16 v[56:71], v[24:27], v[16:19], 0
    v_exp_f32 v40, v40
    v_exp_f32 v41, v41
    v_exp_f32 v42, v42
    v_exp_f32 v43, v43
    v_exp_f32 v44, v44
    v_exp_f32 v45, v45
    v_exp_f32 v46, v46
    v_exp_f32 v47, v47
    v_mfma_f32_32x32x16_bf16 v[56:71], v[28:31], v[20:23], v[56:71]
    v_exp_f32 v48, v48
    v_exp_f32 v49, v49
    v_exp_f32 v50, v50
    v_exp_f32 v51, v51
    v_exp_f32 v52, v52
    v_exp_f32 v53, v53
    v_exp_f32 v54, v54
    v_exp_f32 v55, v55
    v_cvt_pk_bf16_f32 v72, v40, v41
    v_cvt_pk_bf16_f32 v73, v42, v43
    v_cvt_pk_bf16_f32 v74, v44, v45
    v_cvt_pk_bf16_f32 v75, v46, v47
    v_cvt_pk_bf16_f32 v76, v48, v49
    v_cvt_pk_bf16_f32 v77, v50, v51
    v_cvt_pk_bf16_f32 v78, v52, v53
    v_cvt_pk_bf16_f32 v79, v54, v55
    s_waitcnt lgkmcnt(0)
    v_mfma_f32_32x32x16_bf16 v[96:111], v[32:35], v[72:75], v[96:111]
    v_mfma_f32_32x32x16_bf16 v[96:111], v[36:39], v[76:79], v[96:111]
    ds_read_b128 v[32:35], v94 offset:0
    ds_read_b128 v[36:39], v95 offset:0
    s_nop 7
    v_exp_f32 v56, v56
    v_exp_f32 v57, v57
    v_exp_f32 v58, v58
    v_exp_f32 v59, v59
    v_exp_f32 v60, v60
    v_exp_f32 v61, v61
    v_exp_f32 v62, v62
    v_exp_f32 v63, v63
    v_exp_f32 v64, v64
    v_exp_f32 v65, v65
    v_exp_f32 v66, v66
    v_exp_f32 v67, v67
    v_exp_f32 v68, v68
    v_exp_f32 v69, v69
    v_exp_f32 v70, v70
    v_exp_f32 v71, v71
    v_cvt_pk_bf16_f32 v72, v56, v57
    v_cvt_pk_bf16_f32 v73, v58, v59
    v_cvt_pk_bf16_f32 v74, v60, v61
    v_cvt_pk_bf16_f32 v75, v62, v63
    v_cvt_pk_bf16_f32 v76, v64, v65
    v_cvt_pk_bf16_f32 v77, v66, v67
    v_cvt_pk_bf16_f32 v78, v68, v69
    v_cvt_pk_bf16_f32 v79, v70, v71
    s_waitcnt lgkmcnt(0)
    v_mfma_f32_32x32x16_bf16 v[96:111], v[32:35], v[72:75], v[96:111]
    v_mfma_f32_32x32x16_bf16 v[96:111], v[36:39], v[76:79], v[96:111]
    s_waitcnt vmcnt(4)
    s_barrier
    ds_read_b128 v[24:27], v12 offset:16384
    ds_read_b128 v[28:31], v14 offset:16384
    s_add_u32 m0, s46, 0
    s_nop 0
    buffer_load_dwordx4 v6, s[16:19], s40 offen lds
    s_add_u32 s40, s40, 8192
    s_add_u32 m0, s46, 8192
    s_nop 0
    buffer_load_dwordx4 v11, s[20:23], s41 offen lds
    s_add_u32 s41, s41, 256
    s_waitcnt lgkmcnt(0)
    v_mfma_f32_32x32x16_bf16 v[40:55], v[24:27], v[16:19], 0
    v_mfma_f32_32x32x16_bf16 v[40:55], v[28:31], v[20:23], v[40:55]
    ds_read_b128 v[24:27], v12 offset:18432
    ds_read_b128 v[28:31], v14 offset:18432
    ds_read_b128 v[32:35], v88 offset:16384
    ds_read_b128 v[36:39], v89 offset:16384
    s_nop 9
    s_waitcnt lgkmcnt(2)
    v_mfma_f32_32x32x16_bf16 v[56:71], v[24:27], v[16:19], 0
    v_exp_f32 v40, v40
    v_exp_f32 v41, v41
    v_exp_f32 v42, v42
    v_exp_f32 v43, v43
    v_exp_f32 v44, v44
    v_exp_f32 v45, v45
    v_exp_f32 v46, v46
    v_exp_f32 v47, v47
    v_mfma_f32_32x32x16_bf16 v[56:71], v[28:31], v[20:23], v[56:71]
    v_exp_f32 v48, v48
    v_exp_f32 v49, v49
    v_exp_f32 v50, v50
    v_exp_f32 v51, v51
    v_exp_f32 v52, v52
    v_exp_f32 v53, v53
    v_exp_f32 v54, v54
    v_exp_f32 v55, v55
    v_cvt_pk_bf16_f32 v72, v40, v41
    v_cvt_pk_bf16_f32 v73, v42, v43
    v_cvt_pk_bf16_f32 v74, v44, v45
    v_cvt_pk_bf16_f32 v75, v46, v47
    v_cvt_pk_bf16_f32 v76, v48, v49
    v_cvt_pk_bf16_f32 v77, v50, v51
    v_cvt_pk_bf16_f32 v78, v52, v53
    v_cvt_pk_bf16_f32 v79, v54, v55
    s_waitcnt lgkmcnt(0)
    v_mfma_f32_32x32x16_bf16 v[96:111], v[32:35], v[72:75], v[96:111]
    v_mfma_f32_32x32x16_bf16 v[96:111], v[36:39], v[76:79], v[96:111]
    ds_read_b128 v[24:27], v12 offset:20480
    ds_read_b128 v[28:31], v14 offset:20480
    ds_read_b128 v[32:35], v90 offset:16384
    ds_read_b128 v[36:39], v91 offset:16384
    s_waitcnt lgkmcnt(2)
    v_mfma_f32_32x32x16_bf16 v[40:55], v[24:27], v[16:19], 0
    v_exp_f32 v56, v56
    v_exp_f32 v57, v57
    v_exp_f32 v58, v58
    v_exp_f32 v59, v59
    v_exp_f32 v60, v60
    v_exp_f32 v61, v61
    v_exp_f32 v62, v62
    v_exp_f32 v63, v63
    v_mfma_f32_32x32x16_bf16 v[40:55], v[28:31], v[20:23], v[40:55]
    v_exp_f32 v64, v64
    v_exp_f32 v65, v65
    v_exp_f32 v66, v66
    v_exp_f32 v67, v67
    v_exp_f32 v68, v68
    v_exp_f32 v69, v69
    v_exp_f32 v70, v70
    v_exp_f32 v71, v71
    v_cvt_pk_bf16_f32 v72, v56, v57
    v_cvt_pk_bf16_f32 v73, v58, v59
    v_cvt_pk_bf16_f32 v74, v60, v61
    v_cvt_pk_bf16_f32 v75, v62, v63
    v_cvt_pk_bf16_f32 v76, v64, v65
    v_cvt_pk_bf16_f32 v77, v66, v67
    v_cvt_pk_bf16_f32 v78, v68, v69
    v_cvt_pk_bf16_f32 v79, v70, v71
    s_waitcnt lgkmcnt(0)
    v_mfma_f32_32x32x16_bf16 v[96:111], v[32:35], v[72:75], v[96:111]
    v_mfma_f32_32x32x16_bf16 v[96:111], v[36:39], v[76:79], v[96:111]
    ds_read_b128 v[24:27], v12 offset:22528
    ds_read_b128 v[28:31], v14 offset:22528
    ds_read_b128 v[32:35], v92 offset:16384
    ds_read_b128 v[36:39], v93 offset:16384
    s_waitcnt lgkmcnt(2)
    v_mfma_f32_32x32x16_bf16 v[56:71], v[24:27], v[16:19], 0
    v_exp_f32 v40, v40
    v_exp_f32 v41, v41
    v_exp_f32 v42, v42
    v_exp_f32 v43, v43
    v_exp_f32 v44, v44
    v_exp_f32 v45, v45
    v_exp_f32 v46, v46
    v_exp_f32 v47, v47
    v_mfma_f32_32x32x16_bf16 v[56:71], v[28:31], v[20:23], v[56:71]
    v_exp_f32 v48, v48
    v_exp_f32 v49, v49
    v_exp_f32 v50, v50
    v_exp_f32 v51, v51
    v_exp_f32 v52, v52
    v_exp_f32 v53, v53
    v_exp_f32 v54, v54
    v_exp_f32 v55, v55
    v_cvt_pk_bf16_f32 v72, v40, v41
    v_cvt_pk_bf16_f32 v73, v42, v43
    v_cvt_pk_bf16_f32 v74, v44, v45
    v_cvt_pk_bf16_f32 v75, v46, v47
    v_cvt_pk_bf16_f32 v76, v48, v49
    v_cvt_pk_bf16_f32 v77, v50, v51
    v_cvt_pk_bf16_f32 v78, v52, v53
    v_cvt_pk_bf16_f32 v79, v54, v55
    s_waitcnt lgkmcnt(0)
    v_mfma_f32_32x32x16_bf16 v[96:111], v[32:35], v[72:75], v[96:111]
    v_mfma_f32_32x32x16_bf16 v[96:111], v[36:39], v[76:79], v[96:111]
    ds_read_b128 v[32:35], v94 offset:16384
    ds_read_b128 v[36:39], v95 offset:16384
    s_nop 7
    v_exp_f32 v56, v56
    v_exp_f32 v57, v57
    v_exp_f32 v58, v58
    v_exp_f32 v59, v59
    v_exp_f32 v60, v60
    v_exp_f32 v61, v61
    v_exp_f32 v62, v62
    v_exp_f32 v63, v63
    v_exp_f32 v64, v64
    v_exp_f32 v65, v65
    v_exp_f32 v66, v66
    v_exp_f32 v67, v67
    v_exp_f32 v68, v68
    v_exp_f32 v69, v69
    v_exp_f32 v70, v70
    v_exp_f32 v71, v71
    v_cvt_pk_bf16_f32 v72, v56, v57
    v_cvt_pk_bf16_f32 v73, v58, v59
    v_cvt_pk_bf16_f32 v74, v60, v61
    v_cvt_pk_bf16_f32 v75, v62, v63
    v_cvt_pk_bf16_f32 v76, v64, v65
    v_cvt_pk_bf16_f32 v77, v66, v67
    v_cvt_pk_bf16_f32 v78, v68, v69
    v_cvt_pk_bf16_f32 v79, v70, v71
    s_waitcnt lgkmcnt(0)
    v_mfma_f32_32x32x16_bf16 v[96:111], v[32:35], v[72:75], v[96:111]
    v_mfma_f32_32x32x16_bf16 v[96:111], v[36:39], v[76:79], v[96:111]
    s_waitcnt vmcnt(4)
    s_barrier
    ds_read_b128 v[24:27], v12 offset:32768
    ds_read_b128 v[28:31], v14 offset:32768
    s_add_u32 m0, s46, 16384
    s_nop 0
    buffer_load_dwordx4 v6, s[16:19], s40 offen lds
    s_add_u32 s40, s40, 8192
    s_add_u32 m0, s46, 24576
    s_nop 0
    buffer_load_dwordx4 v11, s[20:23], s41 offen lds
    s_add_u32 s41, s41, 256
    s_waitcnt lgkmcnt(0)
    v_mfma_f32_32x32x16_bf16 v[40:55], v[24:27], v[16:19], 0
    v_mfma_f32_32x32x16_bf16 v[40:55], v[28:31], v[20:23], v[40:55]
    ds_read_b128 v[24:27], v12 offset:34816
    ds_read_b128 v[28:31], v14 offset:34816
    ds_read_b128 v[32:35], v88 offset:32768
    ds_read_b128 v[36:39], v89 offset:32768
    s_nop 9
    s_waitcnt lgkmcnt(2)
    v_mfma_f32_32x32x16_bf16 v[56:71], v[24:27], v[16:19], 0
    v_exp_f32 v40, v40
    v_exp_f32 v41, v41
    v_exp_f32 v42, v42
    v_exp_f32 v43, v43
    v_exp_f32 v44, v44
    v_exp_f32 v45, v45
    v_exp_f32 v46, v46
    v_exp_f32 v47, v47
    v_mfma_f32_32x32x16_bf16 v[56:71], v[28:31], v[20:23], v[56:71]
    v_exp_f32 v48, v48
    v_exp_f32 v49, v49
    v_exp_f32 v50, v50
    v_exp_f32 v51, v51
    v_exp_f32 v52, v52
    v_exp_f32 v53, v53
    v_exp_f32 v54, v54
    v_exp_f32 v55, v55
    v_cvt_pk_bf16_f32 v72, v40, v41
    v_cvt_pk_bf16_f32 v73, v42, v43
    v_cvt_pk_bf16_f32 v74, v44, v45
    v_cvt_pk_bf16_f32 v75, v46, v47
    v_cvt_pk_bf16_f32 v76, v48, v49
    v_cvt_pk_bf16_f32 v77, v50, v51
    v_cvt_pk_bf16_f32 v78, v52, v53
    v_cvt_pk_bf16_f32 v79, v54, v55
    s_waitcnt lgkmcnt(0)
    v_mfma_f32_32x32x16_bf16 v[96:111], v[32:35], v[72:75], v[96:111]
    v_mfma_f32_32x32x16_bf16 v[96:111], v[36:39], v[76:79], v[96:111]
    ds_read_b128 v[24:27], v12 offset:36864
    ds_read_b128 v[28:31], v14 offset:36864
    ds_read_b128 v[32:35], v90 offset:32768
    ds_read_b128 v[36:39], v91 offset:32768
    s_waitcnt lgkmcnt(2)
    v_mfma_f32_32x32x16_bf16 v[40:55], v[24:27], v[16:19], 0
    v_exp_f32 v56, v56
    v_exp_f32 v57, v57
    v_exp_f32 v58, v58
    v_exp_f32 v59, v59
    v_exp_f32 v60, v60
    v_exp_f32 v61, v61
    v_exp_f32 v62, v62
    v_exp_f32 v63, v63
    v_mfma_f32_32x32x16_bf16 v[40:55], v[28:31], v[20:23], v[40:55]
    v_exp_f32 v64, v64
    v_exp_f32 v65, v65
    v_exp_f32 v66, v66
    v_exp_f32 v67, v67
    v_exp_f32 v68, v68
    v_exp_f32 v69, v69
    v_exp_f32 v70, v70
    v_exp_f32 v71, v71
    v_cvt_pk_bf16_f32 v72, v56, v57
    v_cvt_pk_bf16_f32 v73, v58, v59
    v_cvt_pk_bf16_f32 v74, v60, v61
    v_cvt_pk_bf16_f32 v75, v62, v63
    v_cvt_pk_bf16_f32 v76, v64, v65
    v_cvt_pk_bf16_f32 v77, v66, v67
    v_cvt_pk_bf16_f32 v78, v68, v69
    v_cvt_pk_bf16_f32 v79, v70, v71
    s_waitcnt lgkmcnt(0)
    v_mfma_f32_32x32x16_bf16 v[96:111], v[32:35], v[72:75], v[96:111]
    v_mfma_f32_32x32x16_bf16 v[96:111], v[36:39], v[76:79], v[96:111]
    ds_read_b128 v[24:27], v12 offset:38912
    ds_read_b128 v[28:31], v14 offset:38912
    ds_read_b128 v[32:35], v92 offset:32768
    ds_read_b128 v[36:39], v93 offset:32768
    s_waitcnt lgkmcnt(2)
    v_mfma_f32_32x32x16_bf16 v[56:71], v[24:27], v[16:19], 0
    v_exp_f32 v40, v40
    v_exp_f32 v41, v41
    v_exp_f32 v42, v42
    v_exp_f32 v43, v43
    v_exp_f32 v44, v44
    v_exp_f32 v45, v45
    v_exp_f32 v46, v46
    v_exp_f32 v47, v47
    v_mfma_f32_32x32x16_bf16 v[56:71], v[28:31], v[20:23], v[56:71]
    v_exp_f32 v48, v48
    v_exp_f32 v49, v49
    v_exp_f32 v50, v50
    v_exp_f32 v51, v51
    v_exp_f32 v52, v52
    v_exp_f32 v53, v53
    v_exp_f32 v54, v54
    v_exp_f32 v55, v55
    v_cvt_pk_bf16_f32 v72, v40, v41
    v_cvt_pk_bf16_f32 v73, v42, v43
    v_cvt_pk_bf16_f32 v74, v44, v45
    v_cvt_pk_bf16_f32 v75, v46, v47
    v_cvt_pk_bf16_f32 v76, v48, v49
    v_cvt_pk_bf16_f32 v77, v50, v51
    v_cvt_pk_bf16_f32 v78, v52, v53
    v_cvt_pk_bf16_f32 v79, v54, v55
    s_waitcnt lgkmcnt(0)
    v_mfma_f32_32x32x16_bf16 v[96:111], v[32:35], v[72:75], v[96:111]
    v_mfma_f32_32x32x16_bf16 v[96:111], v[36:39], v[76:79], v[96:111]
    ds_read_b128 v[32:35], v94 offset:32768
    ds_read_b128 v[36:39], v95 offset:32768
    s_nop 7
    v_exp_f32 v56, v56
    v_exp_f32 v57, v57
    v_exp_f32 v58, v58
    v_exp_f32 v59, v59
    v_exp_f32 v60, v60
    v_exp_f32 v61, v61
    v_exp_f32 v62, v62
    v_exp_f32 v63, v63
    v_exp_f32 v64, v64
    v_exp_f32 v65, v65
    v_exp_f32 v66, v66
    v_exp_f32 v67, v67
    v_exp_f32 v68, v68
    v_exp_f32 v69, v69
    v_exp_f32 v70, v70
    v_exp_f32 v71, v71
    v_cvt_pk_bf16_f32 v72, v56, v57
    v_cvt_pk_bf16_f32 v73, v58, v59
    v_cvt_pk_bf16_f32 v74, v60, v61
    v_cvt_pk_bf16_f32 v75, v62, v63
    v_cvt_pk_bf16_f32 v76, v64, v65
    v_cvt_pk_bf16_f32 v77, v66, v67
    v_cvt_pk_bf16_f32 v78, v68, v69
    v_cvt_pk_bf16_f32 v79, v70, v71
    s_waitcnt lgkmcnt(0)
    v_mfma_f32_32x32x16_bf16 v[96:111], v[32:35], v[72:75], v[96:111]
    v_mfma_f32_32x32x16_bf16 v[96:111], v[36:39], v[76:79], v[96:111]
    s_waitcnt vmcnt(4)
    s_barrier
    ds_read_b128 v[24:27], v12 offset:49152
    ds_read_b128 v[28:31], v14 offset:49152
    s_add_u32 m0, s46, 32768
    s_nop 0
    buffer_load_dwordx4 v6, s[16:19], s40 offen lds
    s_add_u32 s40, s40, 8192
    s_add_u32 m0, s46, 40960
    s_nop 0
    buffer_load_dwordx4 v11, s[20:23], s41 offen lds
    s_add_u32 s41, s41, 256
    s_waitcnt lgkmcnt(0)
    v_mfma_f32_32x32x16_bf16 v[40:55], v[24:27], v[16:19], 0
    v_mfma_f32_32x32x16_bf16 v[40:55], v[28:31], v[20:23], v[40:55]
    ds_read_b128 v[24:27], v12 offset:51200
    ds_read_b128 v[28:31], v14 offset:51200
    ds_read_b128 v[32:35], v88 offset:49152
    ds_read_b128 v[36:39], v89 offset:49152
    s_nop 9
    s_waitcnt lgkmcnt(2)
    v_mfma_f32_32x32x16_bf16 v[56:71], v[24:27], v[16:19], 0
    v_exp_f32 v40, v40
    v_exp_f32 v41, v41
    v_exp_f32 v42, v42
    v_exp_f32 v43, v43
    v_exp_f32 v44, v44
    v_exp_f32 v45, v45
    v_exp_f32 v46, v46
    v_exp_f32 v47, v47
    v_mfma_f32_32x32x16_bf16 v[56:71], v[28:31], v[20:23], v[56:71]
    v_exp_f32 v48, v48
    v_exp_f32 v49, v49
    v_exp_f32 v50, v50
    v_exp_f32 v51, v51
    v_exp_f32 v52, v52
    v_exp_f32 v53, v53
    v_exp_f32 v54, v54
    v_exp_f32 v55, v55
    v_cvt_pk_bf16_f32 v72, v40, v41
    v_cvt_pk_bf16_f32 v73, v42, v43
    v_cvt_pk_bf16_f32 v74, v44, v45
    v_cvt_pk_bf16_f32 v75, v46, v47
    v_cvt_pk_bf16_f32 v76, v48, v49
    v_cvt_pk_bf16_f32 v77, v50, v51
    v_cvt_pk_bf16_f32 v78, v52, v53
    v_cvt_pk_bf16_f32 v79, v54, v55
    s_waitcnt lgkmcnt(0)
    v_mfma_f32_32x32x16_bf16 v[96:111], v[32:35], v[72:75], v[96:111]
    v_mfma_f32_32x32x16_bf16 v[96:111], v[36:39], v[76:79], v[96:111]
    ds_read_b128 v[24:27], v12 offset:53248
    ds_read_b128 v[28:31], v14 offset:53248
    ds_read_b128 v[32:35], v90 offset:49152
    ds_read_b128 v[36:39], v91 offset:49152
    s_waitcnt lgkmcnt(2)
    v_mfma_f32_32x32x16_bf16 v[40:55], v[24:27], v[16:19], 0
    v_exp_f32 v56, v56
    v_exp_f32 v57, v57
    v_exp_f32 v58, v58
    v_exp_f32 v59, v59
    v_exp_f32 v60, v60
    v_exp_f32 v61, v61
    v_exp_f32 v62, v62
    v_exp_f32 v63, v63
    v_mfma_f32_32x32x16_bf16 v[40:55], v[28:31], v[20:23], v[40:55]
    v_exp_f32 v64, v64
    v_exp_f32 v65, v65
    v_exp_f32 v66, v66
    v_exp_f32 v67, v67
    v_exp_f32 v68, v68
    v_exp_f32 v69, v69
    v_exp_f32 v70, v70
    v_exp_f32 v71, v71
    v_cvt_pk_bf16_f32 v72, v56, v57
    v_cvt_pk_bf16_f32 v73, v58, v59
    v_cvt_pk_bf16_f32 v74, v60, v61
    v_cvt_pk_bf16_f32 v75, v62, v63
    v_cvt_pk_bf16_f32 v76, v64, v65
    v_cvt_pk_bf16_f32 v77, v66, v67
    v_cvt_pk_bf16_f32 v78, v68, v69
    v_cvt_pk_bf16_f32 v79, v70, v71
    s_waitcnt lgkmcnt(0)
    v_mfma_f32_32x32x16_bf16 v[96:111], v[32:35], v[72:75], v[96:111]
    v_mfma_f32_32x32x16_bf16 v[96:111], v[36:39], v[76:79], v[96:111]
    ds_read_b128 v[24:27], v12 offset:55296
    ds_read_b128 v[28:31], v14 offset:55296
    ds_read_b128 v[32:35], v92 offset:49152
    ds_read_b128 v[36:39], v93 offset:49152
    s_waitcnt lgkmcnt(2)
    v_mfma_f32_32x32x16_bf16 v[56:71], v[24:27], v[16:19], 0
    v_exp_f32 v40, v40
    v_exp_f32 v41, v41
    v_exp_f32 v42, v42
    v_exp_f32 v43, v43
    v_exp_f32 v44, v44
    v_exp_f32 v45, v45
    v_exp_f32 v46, v46
    v_exp_f32 v47, v47
    v_mfma_f32_32x32x16_bf16 v[56:71], v[28:31], v[20:23], v[56:71]
    v_exp_f32 v48, v48
    v_exp_f32 v49, v49
    v_exp_f32 v50, v50
    v_exp_f32 v51, v51
    v_exp_f32 v52, v52
    v_exp_f32 v53, v53
    v_exp_f32 v54, v54
    v_exp_f32 v55, v55
    v_cvt_pk_bf16_f32 v72, v40, v41
    v_cvt_pk_bf16_f32 v73, v42, v43
    v_cvt_pk_bf16_f32 v74, v44, v45
    v_cvt_pk_bf16_f32 v75, v46, v47
    v_cvt_pk_bf16_f32 v76, v48, v49
    v_cvt_pk_bf16_f32 v77, v50, v51
    v_cvt_pk_bf16_f32 v78, v52, v53
    v_cvt_pk_bf16_f32 v79, v54, v55
    s_waitcnt lgkmcnt(0)
    v_mfma_f32_32x32x16_bf16 v[96:111], v[32:35], v[72:75], v[96:111]
    v_mfma_f32_32x32x16_bf16 v[96:111], v[36:39], v[76:79], v[96:111]
    ds_read_b128 v[32:35], v94 offset:49152
    ds_read_b128 v[36:39], v95 offset:49152
    s_nop 7
    v_exp_f32 v56, v56
    v_exp_f32 v57, v57
    v_exp_f32 v58, v58
    v_exp_f32 v59, v59
    v_exp_f32 v60, v60
    v_exp_f32 v61, v61
    v_exp_f32 v62, v62
    v_exp_f32 v63, v63
    v_exp_f32 v64, v64
    v_exp_f32 v65, v65
    v_exp_f32 v66, v66
    v_exp_f32 v67, v67
    v_exp_f32 v68, v68
    v_exp_f32 v69, v69
    v_exp_f32 v70, v70
    v_exp_f32 v71, v71
    v_cvt_pk_bf16_f32 v72, v56, v57
    v_cvt_pk_bf16_f32 v73, v58, v59
    v_cvt_pk_bf16_f32 v74, v60, v61
    v_cvt_pk_bf16_f32 v75, v62, v63
    v_cvt_pk_bf16_f32 v76, v64, v65
    v_cvt_pk_bf16_f32 v77, v66, v67
    v_cvt_pk_bf16_f32 v78, v68, v69
    v_cvt_pk_bf16_f32 v79, v70, v71
    s_waitcnt lgkmcnt(0)
    v_mfma_f32_32x32x16_bf16 v[96:111], v[32:35], v[72:75], v[96:111]
    v_mfma_f32_32x32x16_bf16 v[96:111], v[36:39], v[76:79], v[96:111]
    s_sub_u32 s42, s42, 1
    s_cmp_lg_u32 s42, 0
    s_cbranch_scc1 attn_p2
    s_waitcnt vmcnt(0)
    s_nop 15
    v_mov_b32 v48, v106
    v_mov_b32 v49, v106
    s_nop 1
    v_permlane32_swap_b32 v48, v49
    v_rcp_f32 v48, v48
    s_mul_i32 s34, s30, 36
    s_lshl_b32 s35, s31, 8
    v_lshl_add_u32 v50, v2, 5, v3
    v_add_u32 v50, s35, v50
    v_mul_u32_u24 v50, 1152, v50
    v_lshl_add_u32 v50, v4, 3, v50
    v_add_u32 v50, s34, v50

    v_mul_f32 v96, v96, v48
    v_mul_f32 v97, v97, v48
    v_mul_f32 v98, v98, v48
    v_mul_f32 v99, v99, v48
    v_mul_f32 v100, v100, v48
    v_mul_f32 v101, v101, v48
    v_mul_f32 v102, v102, v48
    v_mul_f32 v103, v103, v48
    v_mul_f32 v104, v104, v48
    v_mul_f32 v105, v105, v48
    v_mul_f32 v106, v106, v48
    v_mul_f32 v107, v107, v48
    v_cvt_pk_bf16_f32 v72, v96, v97
    v_cvt_pk_bf16_f32 v73, v98, v99
    v_cvt_pk_bf16_f32 v74, v100, v101
    v_cvt_pk_bf16_f32 v75, v102, v103
    v_cvt_pk_bf16_f32 v76, v104, v105
    v_cvt_pk_bf16_f32 v77, v106, v107
    buffer_store_dword v72, v50, s[24:27], 0 offen
    buffer_store_dword v73, v50, s[24:27], 0 offen offset:4
    buffer_store_dword v74, v50, s[24:27], 0 offen offset:16
    buffer_store_dword v75, v50, s[24:27], 0 offen offset:20
    v_cmp_gt_u32 vcc, 32, v1
    s_and_saveexec_b64 s[36:37], vcc
    buffer_store_dword v76, v50, s[24:27], 0 offen offset:32
    s_mov_b64 exec, s[36:37]
attn_kernel_done:
    s_endpgm

.globl wo_kernel
.p2align 8
.type wo_kernel,@function
wo_kernel:
    s_cmp_ge_u32 s2, 288
    s_cbranch_scc1 wo_kernel_done
    s_load_dwordx2 s[8:9], s[0:1], 88

    s_load_dwordx2 s[36:37], s[0:1], 16
    s_load_dwordx2 s[6:7], s[0:1], 0
    s_waitcnt lgkmcnt(0)
    s_add_u32 s12, s8, 16777216
    s_addc_u32 s13, s9, 0
    s_mov_b32 s14, 2359296
    s_mov_b32 s15, 0x00020000
    s_mov_b32 s16, s36
    s_mov_b32 s17, s37
    s_mov_b32 s18, 663552
    s_mov_b32 s19, 0x00020000
    s_and_b32 s29, s2, 7
    s_mul_i32 s29, s29, 36
    s_lshr_b32 s30, s2, 3
    s_add_u32 s29, s29, s30
    s_mov_b32 s30, 477218589
    s_mul_hi_u32 s31, s29, s30
    s_mul_i32 s32, s31, 9
    s_sub_u32 s32, s29, s32

    s_mul_i32 s33, s31, 64
    s_mul_i32 s34, s32, 64
    v_and_b32 v1, 63, v0
    v_lshrrev_b32 v15, 6, v0
    s_nop 1
    v_readfirstlane_b32 s45, v15
    v_lshrrev_b32 v48, 2, v1
    v_and_b32 v49, 3, v1
    v_lshrrev_b32 v50, 4, v1
    v_xor_b32 v49, v49, v50
    v_lshl_add_u32 v51, v15, 4, v48
    v_add_u32 v51, s33, v51
    v_mov_b32 v52, 1152

    v_add_u32 v53, 0, v51
    v_mul_lo_u32 v2, v53, v52
    v_lshl_add_u32 v2, v49, 4, v2
    v_lshrrev_b32 v48, 3, v1
    v_and_b32 v49, 7, v1
    v_lshrrev_b32 v50, 4, v1
    v_and_b32 v50, 1, v50
    v_lshlrev_b32 v50, 2, v50
    v_xor_b32 v49, v49, v50
    v_lshl_add_u32 v51, v15, 3, v48

    v_mov_b32 v52, 1152
    s_lshl_b32 s35, s34, 1
    v_add_u32 v53, 0, v51
    v_mul_lo_u32 v3, v53, v52
    v_lshl_add_u32 v3, v49, 4, v3
    v_add_u32 v3, s35, v3
    v_lshrrev_b32 v48, 1, v15
    v_and_b32 v49, 1, v15
    v_and_b32 v50, 31, v1
    v_lshrrev_b32 v51, 5, v1
    v_mul_u32_u24 v52, 32, v48
    v_add_u32 v52, v52, v50
    v_lshlrev_b32 v52, 6, v52
    v_lshrrev_b32 v53, 2, v50
    v_and_b32 v53, 3, v53
    v_xor_b32 v54, v51, v53
    v_lshl_add_u32 v4, v54, 4, v52
    v_xor_b32 v54, 2, v54
    v_lshl_add_u32 v5, v54, 4, v52

    v_and_b32 v53, 15, v1
    v_lshrrev_b32 v54, 2, v53
    v_lshl_add_u32 v55, v51, 3, v54
    v_mul_u32_u24 v55, 128, v55
    v_and_b32 v56, 3, v53
    v_and_b32 v57, 1, v56
    v_lshl_add_u32 v55, v57, 3, v55
    v_add_u32 v55, 4096, v55
    v_lshrrev_b32 v56, 1, v56
    v_lshrrev_b32 v57, 4, v1
    v_and_b32 v57, 1, v57
    v_lshl_add_u32 v56, v57, 1, v56
    v_lshl_add_u32 v56, v49, 2, v56

    v_lshrrev_b32 v57, 1, v54
    v_lshlrev_b32 v57, 2, v57
    v_add_u32 v58, 0, v56
    v_xor_b32 v58, v58, v57
    v_lshl_add_u32 v6, v58, 4, v55
    v_add_u32 v7, 0x10000, v4
    v_add_u32 v8, 0x10000, v5
    v_add_u32 v9, 0x10000, v6
    v_mov_b32 v32, 0
    v_mov_b32 v33, 0
    v_mov_b32 v34, 0
    v_mov_b32 v35, 0
    v_mov_b32 v36, 0
    v_mov_b32 v37, 0
    v_mov_b32 v38, 0
    v_mov_b32 v39, 0
    v_mov_b32 v40, 0
    v_mov_b32 v41, 0
    v_mov_b32 v42, 0
    v_mov_b32 v43, 0
    v_mov_b32 v44, 0
    v_mov_b32 v45, 0
    v_mov_b32 v46, 0
    v_mov_b32 v47, 0
    s_lshl_b32 s46, s45, 10
    s_mov_b32 s40, 0
    s_mov_b32 s41, 0
    s_add_u32 m0, s46, 0
    s_nop 0
    buffer_load_dwordx4 v2, s[12:15], s40 offen lds
    s_add_u32 m0, s46, 4096
    s_nop 0
    buffer_load_dwordx4 v3, s[16:19], s41 offen lds
    s_add_u32 s40, s40, 64
    s_add_u32 s41, s41, 36864
    s_add_u32 m0, s46, 8192
    s_nop 0
    buffer_load_dwordx4 v2, s[12:15], s40 offen lds
    s_add_u32 m0, s46, 12288
    s_nop 0
    buffer_load_dwordx4 v3, s[16:19], s41 offen lds
    s_add_u32 s40, s40, 64
    s_add_u32 s41, s41, 36864
    s_mov_b32 s42, 6
wo_kernel_loop:
    s_waitcnt vmcnt(2)
    s_barrier
    ds_read_b128 v[16:19], v4 offset:0
    ds_read_b64_tr_b16 v[24:25], v6 offset:0
    ds_read_b64_tr_b16 v[26:27], v6 offset:512
    ds_read_b128 v[20:23], v5 offset:0
    ds_read_b64_tr_b16 v[28:29], v6 offset:2048
    ds_read_b64_tr_b16 v[30:31], v6 offset:2560
    s_add_u32 m0, s46, 16384
    s_nop 0
    buffer_load_dwordx4 v2, s[12:15], s40 offen lds
    s_add_u32 m0, s46, 20480
    s_nop 0
    buffer_load_dwordx4 v3, s[16:19], s41 offen lds
    s_add_u32 s40, s40, 64
    s_add_u32 s41, s41, 36864
    s_waitcnt lgkmcnt(3)
    v_mfma_f32_32x32x16_bf16 v[32:47], v[24:27], v[16:19], v[32:47]
    s_waitcnt lgkmcnt(0)
    v_mfma_f32_32x32x16_bf16 v[32:47], v[28:31], v[20:23], v[32:47]
    s_waitcnt vmcnt(2)
    s_barrier
    ds_read_b128 v[16:19], v4 offset:8192
    ds_read_b64_tr_b16 v[24:25], v6 offset:8192
    ds_read_b64_tr_b16 v[26:27], v6 offset:8704
    ds_read_b128 v[20:23], v5 offset:8192
    ds_read_b64_tr_b16 v[28:29], v6 offset:10240
    ds_read_b64_tr_b16 v[30:31], v6 offset:10752
    s_add_u32 m0, s46, 0
    s_nop 0
    buffer_load_dwordx4 v2, s[12:15], s40 offen lds
    s_add_u32 m0, s46, 4096
    s_nop 0
    buffer_load_dwordx4 v3, s[16:19], s41 offen lds
    s_add_u32 s40, s40, 64
    s_add_u32 s41, s41, 36864
    s_waitcnt lgkmcnt(3)
    v_mfma_f32_32x32x16_bf16 v[32:47], v[24:27], v[16:19], v[32:47]
    s_waitcnt lgkmcnt(0)
    v_mfma_f32_32x32x16_bf16 v[32:47], v[28:31], v[20:23], v[32:47]
    s_waitcnt vmcnt(2)
    s_barrier
    ds_read_b128 v[16:19], v4 offset:16384
    ds_read_b64_tr_b16 v[24:25], v6 offset:16384
    ds_read_b64_tr_b16 v[26:27], v6 offset:16896
    ds_read_b128 v[20:23], v5 offset:16384
    ds_read_b64_tr_b16 v[28:29], v6 offset:18432
    ds_read_b64_tr_b16 v[30:31], v6 offset:18944
    s_add_u32 m0, s46, 8192
    s_nop 0
    buffer_load_dwordx4 v2, s[12:15], s40 offen lds
    s_add_u32 m0, s46, 12288
    s_nop 0
    buffer_load_dwordx4 v3, s[16:19], s41 offen lds
    s_add_u32 s40, s40, 64
    s_add_u32 s41, s41, 36864
    s_waitcnt lgkmcnt(3)
    v_mfma_f32_32x32x16_bf16 v[32:47], v[24:27], v[16:19], v[32:47]
    s_waitcnt lgkmcnt(0)
    v_mfma_f32_32x32x16_bf16 v[32:47], v[28:31], v[20:23], v[32:47]
    s_sub_u32 s42, s42, 1
    s_cmp_lg_u32 s42, 0
    s_cbranch_scc1 wo_kernel_loop
    s_waitcnt vmcnt(0)
    s_nop 15
    v_lshrrev_b32 v48, 1, v15
    v_and_b32 v49, 1, v15
    v_and_b32 v50, 31, v1
    v_lshrrev_b32 v51, 5, v1
    v_mul_u32_u24 v52, 32, v48
    v_add3_u32 v52, v52, v50, s33
    v_mul_u32_u24 v53, 32, v49
    v_lshl_add_u32 v53, v51, 2, v53
    v_add_u32 v53, s34, v53

    s_mov_b32 s20, s8
    s_mov_b32 s21, s9
    s_mov_b32 s22, 13824
    s_mov_b32 s23, 0x00020000
    s_mov_b32 s24, s6
    s_mov_b32 s25, s7
    s_mov_b32 s26, 2359296
    s_mov_b32 s27, 0x00020000
    s_add_u32 s28, s8, 20971520
    s_addc_u32 s29, s9, 0
    s_mov_b32 s30, 2359296
    s_mov_b32 s31, 0x00020000
    v_add_u32 v54, 0, v53
    v_add_u32 v55, 0, v52
    v_mul_u32_u24 v56, 1152, v55
    v_lshl_add_u32 v56, v54, 1, v56
    v_lshlrev_b32 v57, 2, v54
    v_add_u32 v57, 4608, v57
    buffer_load_dwordx4 v[60:63], v57, s[20:23], 0 offen
    buffer_load_dwordx2 v[58:59], v56, s[24:27], 0 offen
    s_waitcnt vmcnt(0)
    v_lshlrev_b32 v64, 16, v58
    v_and_b32 v65, 0xffff0000, v58
    v_lshlrev_b32 v66, 16, v59
    v_and_b32 v67, 0xffff0000, v59
    v_fmac_f32 v64, v32, v60
    v_fmac_f32 v65, v33, v61
    v_fmac_f32 v66, v34, v62
    v_fmac_f32 v67, v35, v63
    v_cvt_pk_bf16_f32 v58, v64, v65
    v_cvt_pk_bf16_f32 v59, v66, v67
    buffer_store_dwordx2 v[58:59], v56, s[28:31], 0 offen
    v_add_u32 v54, 8, v53
    v_add_u32 v55, 0, v52
    v_mul_u32_u24 v56, 1152, v55
    v_lshl_add_u32 v56, v54, 1, v56
    v_lshlrev_b32 v57, 2, v54
    v_add_u32 v57, 4608, v57
    buffer_load_dwordx4 v[60:63], v57, s[20:23], 0 offen
    buffer_load_dwordx2 v[58:59], v56, s[24:27], 0 offen
    s_waitcnt vmcnt(0)
    v_lshlrev_b32 v64, 16, v58
    v_and_b32 v65, 0xffff0000, v58
    v_lshlrev_b32 v66, 16, v59
    v_and_b32 v67, 0xffff0000, v59
    v_fmac_f32 v64, v36, v60
    v_fmac_f32 v65, v37, v61
    v_fmac_f32 v66, v38, v62
    v_fmac_f32 v67, v39, v63
    v_cvt_pk_bf16_f32 v58, v64, v65
    v_cvt_pk_bf16_f32 v59, v66, v67
    buffer_store_dwordx2 v[58:59], v56, s[28:31], 0 offen
    v_add_u32 v54, 16, v53
    v_add_u32 v55, 0, v52
    v_mul_u32_u24 v56, 1152, v55
    v_lshl_add_u32 v56, v54, 1, v56
    v_lshlrev_b32 v57, 2, v54
    v_add_u32 v57, 4608, v57
    buffer_load_dwordx4 v[60:63], v57, s[20:23], 0 offen
    buffer_load_dwordx2 v[58:59], v56, s[24:27], 0 offen
    s_waitcnt vmcnt(0)
    v_lshlrev_b32 v64, 16, v58
    v_and_b32 v65, 0xffff0000, v58
    v_lshlrev_b32 v66, 16, v59
    v_and_b32 v67, 0xffff0000, v59
    v_fmac_f32 v64, v40, v60
    v_fmac_f32 v65, v41, v61
    v_fmac_f32 v66, v42, v62
    v_fmac_f32 v67, v43, v63
    v_cvt_pk_bf16_f32 v58, v64, v65
    v_cvt_pk_bf16_f32 v59, v66, v67
    buffer_store_dwordx2 v[58:59], v56, s[28:31], 0 offen
    v_add_u32 v54, 24, v53
    v_add_u32 v55, 0, v52
    v_mul_u32_u24 v56, 1152, v55
    v_lshl_add_u32 v56, v54, 1, v56
    v_lshlrev_b32 v57, 2, v54
    v_add_u32 v57, 4608, v57
    buffer_load_dwordx4 v[60:63], v57, s[20:23], 0 offen
    buffer_load_dwordx2 v[58:59], v56, s[24:27], 0 offen
    s_waitcnt vmcnt(0)
    v_lshlrev_b32 v64, 16, v58
    v_and_b32 v65, 0xffff0000, v58
    v_lshlrev_b32 v66, 16, v59
    v_and_b32 v67, 0xffff0000, v59
    v_fmac_f32 v64, v44, v60
    v_fmac_f32 v65, v45, v61
    v_fmac_f32 v66, v46, v62
    v_fmac_f32 v67, v47, v63
    v_cvt_pk_bf16_f32 v58, v64, v65
    v_cvt_pk_bf16_f32 v59, v66, v67
    buffer_store_dwordx2 v[58:59], v56, s[28:31], 0 offen
wo_kernel_done:
    s_endpgm

.globl ln2_kernel
.p2align 8
.type ln2_kernel,@function
ln2_kernel:
    s_cmp_ge_u32 s2, 256
    s_cbranch_scc1 ln2_kernel_done
    s_load_dwordx2 s[4:5], s[0:1], 0
    s_load_dwordx2 s[8:9], s[0:1], 88
    s_waitcnt lgkmcnt(0)

    s_add_u32 s12, s8, 20971520
    s_addc_u32 s13, s9, 0
    s_mov_b32 s14, 2359296
    s_mov_b32 s15, 0x00020000
    s_add_u32 s16, s8, 25165824
    s_addc_u32 s17, s9, 0
    s_mov_b32 s18, 2359296
    s_mov_b32 s19, 0x00020000
    s_mov_b32 s20, s8
    s_mov_b32 s21, s9
    s_mov_b32 s22, 13824
    s_mov_b32 s23, 0x00020000
    v_and_b32 v1, 31, v0
    v_lshrrev_b32 v2, 5, v0
    s_lshl_b32 s3, s2, 3
    v_add_u32 v2, s3, v2
    v_mul_u32_u24 v3, 1152, v2
    v_lshl_add_u32 v3, v1, 2, v3
    v_lshlrev_b32 v4, 3, v1

    v_add_u32 v89, 9216, v4
    v_add_u32 v90, 6912, v4
    buffer_load_dword v10, v3, s[12:15], 0 offen offset:0
    buffer_load_dword v11, v3, s[12:15], 0 offen offset:128
    buffer_load_dword v12, v3, s[12:15], 0 offen offset:256
    buffer_load_dword v13, v3, s[12:15], 0 offen offset:384
    buffer_load_dword v14, v3, s[12:15], 0 offen offset:512
    buffer_load_dword v15, v3, s[12:15], 0 offen offset:640
    buffer_load_dword v16, v3, s[12:15], 0 offen offset:768
    buffer_load_dword v17, v3, s[12:15], 0 offen offset:896
    buffer_load_dword v18, v3, s[12:15], 0 offen offset:1024
    buffer_load_dwordx2 v[40:41], v89, s[20:23], 0 offen offset:0
    buffer_load_dwordx2 v[60:61], v90, s[20:23], 0 offen offset:0
    buffer_load_dwordx2 v[42:43], v89, s[20:23], 0 offen offset:256
    buffer_load_dwordx2 v[62:63], v90, s[20:23], 0 offen offset:256
    buffer_load_dwordx2 v[44:45], v89, s[20:23], 0 offen offset:512
    buffer_load_dwordx2 v[64:65], v90, s[20:23], 0 offen offset:512
    buffer_load_dwordx2 v[46:47], v89, s[20:23], 0 offen offset:768
    buffer_load_dwordx2 v[66:67], v90, s[20:23], 0 offen offset:768
    buffer_load_dwordx2 v[48:49], v89, s[20:23], 0 offen offset:1024
    buffer_load_dwordx2 v[68:69], v90, s[20:23], 0 offen offset:1024
    buffer_load_dwordx2 v[50:51], v89, s[20:23], 0 offen offset:1280
    buffer_load_dwordx2 v[70:71], v90, s[20:23], 0 offen offset:1280
    buffer_load_dwordx2 v[52:53], v89, s[20:23], 0 offen offset:1536
    buffer_load_dwordx2 v[72:73], v90, s[20:23], 0 offen offset:1536
    buffer_load_dwordx2 v[54:55], v89, s[20:23], 0 offen offset:1792
    buffer_load_dwordx2 v[74:75], v90, s[20:23], 0 offen offset:1792
    buffer_load_dwordx2 v[56:57], v89, s[20:23], 0 offen offset:2048
    buffer_load_dwordx2 v[76:77], v90, s[20:23], 0 offen offset:2048
    s_waitcnt vmcnt(18)
    v_lshlrev_b32 v20, 16, v10
    v_and_b32 v21, 0xffff0000, v10
    v_lshlrev_b32 v22, 16, v11
    v_and_b32 v23, 0xffff0000, v11
    v_lshlrev_b32 v24, 16, v12
    v_and_b32 v25, 0xffff0000, v12
    v_lshlrev_b32 v26, 16, v13
    v_and_b32 v27, 0xffff0000, v13
    v_lshlrev_b32 v28, 16, v14
    v_and_b32 v29, 0xffff0000, v14
    v_lshlrev_b32 v30, 16, v15
    v_and_b32 v31, 0xffff0000, v15
    v_lshlrev_b32 v32, 16, v16
    v_and_b32 v33, 0xffff0000, v16
    v_lshlrev_b32 v34, 16, v17
    v_and_b32 v35, 0xffff0000, v17
    v_lshlrev_b32 v36, 16, v18
    v_and_b32 v37, 0xffff0000, v18
    v_add_f32 v8, v20, v21
    v_add_f32 v8, v8, v22
    v_add_f32 v8, v8, v23
    v_add_f32 v8, v8, v24
    v_add_f32 v8, v8, v25
    v_add_f32 v8, v8, v26
    v_add_f32 v8, v8, v27
    v_add_f32 v8, v8, v28
    v_add_f32 v8, v8, v29
    v_add_f32 v8, v8, v30
    v_add_f32 v8, v8, v31
    v_add_f32 v8, v8, v32
    v_add_f32 v8, v8, v33
    v_add_f32 v8, v8, v34
    v_add_f32 v8, v8, v35
    v_add_f32 v8, v8, v36
    v_add_f32 v8, v8, v37
    ds_swizzle_b32 v9, v8 offset:1055
    s_waitcnt lgkmcnt(0)
    v_add_f32 v8, v8, v9
    ds_swizzle_b32 v9, v8 offset:2079
    s_waitcnt lgkmcnt(0)
    v_add_f32 v8, v8, v9
    ds_swizzle_b32 v9, v8 offset:4127
    s_waitcnt lgkmcnt(0)
    v_add_f32 v8, v8, v9
    ds_swizzle_b32 v9, v8 offset:8223
    s_waitcnt lgkmcnt(0)
    v_add_f32 v8, v8, v9
    ds_swizzle_b32 v9, v8 offset:16415
    s_waitcnt lgkmcnt(0)
    v_add_f32 v8, v8, v9
    v_mul_f32 v8, 0x3ae38e39, v8
    v_sub_f32 v20, v20, v8
    v_sub_f32 v21, v21, v8
    v_sub_f32 v22, v22, v8
    v_sub_f32 v23, v23, v8
    v_sub_f32 v24, v24, v8
    v_sub_f32 v25, v25, v8
    v_sub_f32 v26, v26, v8
    v_sub_f32 v27, v27, v8
    v_sub_f32 v28, v28, v8
    v_sub_f32 v29, v29, v8
    v_sub_f32 v30, v30, v8
    v_sub_f32 v31, v31, v8
    v_sub_f32 v32, v32, v8
    v_sub_f32 v33, v33, v8
    v_sub_f32 v34, v34, v8
    v_sub_f32 v35, v35, v8
    v_sub_f32 v36, v36, v8
    v_sub_f32 v37, v37, v8
    v_mul_f32 v8, v20, v20
    v_fmac_f32 v8, v21, v21
    v_fmac_f32 v8, v22, v22
    v_fmac_f32 v8, v23, v23
    v_fmac_f32 v8, v24, v24
    v_fmac_f32 v8, v25, v25
    v_fmac_f32 v8, v26, v26
    v_fmac_f32 v8, v27, v27
    v_fmac_f32 v8, v28, v28
    v_fmac_f32 v8, v29, v29
    v_fmac_f32 v8, v30, v30
    v_fmac_f32 v8, v31, v31
    v_fmac_f32 v8, v32, v32
    v_fmac_f32 v8, v33, v33
    v_fmac_f32 v8, v34, v34
    v_fmac_f32 v8, v35, v35
    v_fmac_f32 v8, v36, v36
    v_fmac_f32 v8, v37, v37
    ds_swizzle_b32 v9, v8 offset:1055
    s_waitcnt lgkmcnt(0)
    v_add_f32 v8, v8, v9
    ds_swizzle_b32 v9, v8 offset:2079
    s_waitcnt lgkmcnt(0)
    v_add_f32 v8, v8, v9
    ds_swizzle_b32 v9, v8 offset:4127
    s_waitcnt lgkmcnt(0)
    v_add_f32 v8, v8, v9
    ds_swizzle_b32 v9, v8 offset:8223
    s_waitcnt lgkmcnt(0)
    v_add_f32 v8, v8, v9
    ds_swizzle_b32 v9, v8 offset:16415
    s_waitcnt lgkmcnt(0)
    v_add_f32 v8, v8, v9
    v_mov_b32 v9, 0x3727c5ac
    v_fmac_f32 v9, 0x3ae38e39, v8
    v_rsq_f32 v9, v9
    s_waitcnt vmcnt(0)

    v_mul_f32 v20, v20, v9
    v_fma_f32 v20, v20, v40, v60
    v_mul_f32 v21, v21, v9
    v_fma_f32 v21, v21, v41, v61
    v_mul_f32 v22, v22, v9
    v_fma_f32 v22, v22, v42, v62
    v_mul_f32 v23, v23, v9
    v_fma_f32 v23, v23, v43, v63
    v_mul_f32 v24, v24, v9
    v_fma_f32 v24, v24, v44, v64
    v_mul_f32 v25, v25, v9
    v_fma_f32 v25, v25, v45, v65
    v_mul_f32 v26, v26, v9
    v_fma_f32 v26, v26, v46, v66
    v_mul_f32 v27, v27, v9
    v_fma_f32 v27, v27, v47, v67
    v_mul_f32 v28, v28, v9
    v_fma_f32 v28, v28, v48, v68
    v_mul_f32 v29, v29, v9
    v_fma_f32 v29, v29, v49, v69
    v_mul_f32 v30, v30, v9
    v_fma_f32 v30, v30, v50, v70
    v_mul_f32 v31, v31, v9
    v_fma_f32 v31, v31, v51, v71
    v_mul_f32 v32, v32, v9
    v_fma_f32 v32, v32, v52, v72
    v_mul_f32 v33, v33, v9
    v_fma_f32 v33, v33, v53, v73
    v_mul_f32 v34, v34, v9
    v_fma_f32 v34, v34, v54, v74
    v_mul_f32 v35, v35, v9
    v_fma_f32 v35, v35, v55, v75
    v_mul_f32 v36, v36, v9
    v_fma_f32 v36, v36, v56, v76
    v_mul_f32 v37, v37, v9
    v_fma_f32 v37, v37, v57, v77
    v_cvt_pk_bf16_f32 v10, v20, v21
    buffer_store_dword v10, v3, s[16:19], 0 offen offset:0
    v_cvt_pk_bf16_f32 v11, v22, v23
    buffer_store_dword v11, v3, s[16:19], 0 offen offset:128
    v_cvt_pk_bf16_f32 v12, v24, v25
    buffer_store_dword v12, v3, s[16:19], 0 offen offset:256
    v_cvt_pk_bf16_f32 v13, v26, v27
    buffer_store_dword v13, v3, s[16:19], 0 offen offset:384
    v_cvt_pk_bf16_f32 v14, v28, v29
    buffer_store_dword v14, v3, s[16:19], 0 offen offset:512
    v_cvt_pk_bf16_f32 v15, v30, v31
    buffer_store_dword v15, v3, s[16:19], 0 offen offset:640
    v_cvt_pk_bf16_f32 v16, v32, v33
    buffer_store_dword v16, v3, s[16:19], 0 offen offset:768
    v_cvt_pk_bf16_f32 v17, v34, v35
    buffer_store_dword v17, v3, s[16:19], 0 offen offset:896
    v_cvt_pk_bf16_f32 v18, v36, v37
    buffer_store_dword v18, v3, s[16:19], 0 offen offset:1024
ln2_kernel_done:
    s_endpgm

.globl gu_kernel
.p2align 8
.type gu_kernel,@function
gu_kernel:
    s_cmp_ge_u32 s2, 256
    s_cbranch_scc1 gu_kernel_done
    s_load_dwordx2 s[8:9], s[0:1], 88

    s_load_dwordx2 s[36:37], s[0:1], 32
    s_load_dwordx2 s[38:39], s[0:1], 40
    s_waitcnt lgkmcnt(0)
    s_add_u32 s12, s8, 25165824
    s_addc_u32 s13, s9, 0
    s_mov_b32 s14, 2359296
    s_mov_b32 s15, 0x00020000
    s_mov_b32 s16, s36
    s_mov_b32 s17, s37
    s_mov_b32 s18, 5308416
    s_mov_b32 s19, 0x00020000
    s_mov_b32 s20, s38
    s_mov_b32 s21, s39
    s_mov_b32 s22, 5308416
    s_mov_b32 s23, 0x00020000
    s_and_b32 s29, s2, 7
    s_mul_i32 s29, s29, 32
    s_lshr_b32 s30, s2, 3
    s_add_u32 s29, s29, s30

    s_mov_b32 s47, 0
    s_mov_b32 s30, 536870913
    s_mul_hi_u32 s31, s29, s30
    s_mul_i32 s32, s31, 8
    s_sub_u32 s32, s29, s32

    s_mul_i32 s33, s32, 256
    s_mul_i32 s34, s31, 144
    v_and_b32 v1, 63, v0
    v_lshrrev_b32 v15, 6, v0
    s_nop 1
    v_readfirstlane_b32 s45, v15
    v_lshrrev_b32 v16, 2, v1
    v_and_b32 v17, 3, v1
    v_lshrrev_b32 v18, 4, v1
    v_xor_b32 v17, v17, v18
    v_lshl_add_u32 v19, v15, 4, v16
    v_add_u32 v19, s33, v19
    v_mov_b32 v20, 1152

    v_add_u32 v21, 0, v19
    v_mul_lo_u32 v2, v21, v20
    v_lshl_add_u32 v2, v17, 4, v2
    v_add_u32 v21, 128, v19
    v_mul_lo_u32 v3, v21, v20
    v_lshl_add_u32 v3, v17, 4, v3
    v_mov_b32 v20, 9216
    s_lshl_b32 s35, s34, 1
    v_mov_b32 v22, 58255
    v_lshl_add_u32 v16, v15, 6, v1
    v_add_u32 v16, 0, v16
    v_mul_u32_u24 v17, v16, v22
    v_lshrrev_b32 v17, 20, v17
    v_mul_u32_u24 v18, 18, v17
    v_sub_u32 v18, v16, v18
    v_mul_lo_u32 v4, v17, v20
    v_lshl_add_u32 v4, v18, 4, v4
    v_add_u32 v4, s35, v4
    v_mul_u32_u24 v16, 8, v15
    v_add_u32 v16, v16, v1
    v_add_u32 v16, 512, v16
    v_mul_u32_u24 v17, v16, v22
    v_lshrrev_b32 v17, 20, v17
    v_mul_u32_u24 v18, 18, v17
    v_sub_u32 v18, v16, v18
    v_mul_lo_u32 v5, v17, v20
    v_lshl_add_u32 v5, v18, 4, v5
    v_add_u32 v5, s35, v5
    v_and_b32 v18, 15, v1
    v_lshrrev_b32 v19, 4, v1
    v_mul_u32_u24 v20, 32, v15
    v_add_u32 v20, v20, v18
    v_lshlrev_b32 v20, 6, v20
    v_lshrrev_b32 v21, 2, v18
    v_xor_b32 v22, v19, v21
    v_lshl_add_u32 v6, v22, 4, v20
    v_lshl_add_u32 v23, v19, 3, v21
    v_mul_u32_u24 v23, 288, v23
    v_and_b32 v24, 3, v18
    v_lshl_add_u32 v7, v24, 3, v23
    v_add_u32 v7, 16384, v7
    v_add_u32 v8, 0x10000, v6
    v_add_u32 v9, 0x10000, v7

    v_mov_b32 v96, 0
    v_mov_b32 v97, 0
    v_mov_b32 v98, 0
    v_mov_b32 v99, 0
    v_mov_b32 v100, 0
    v_mov_b32 v101, 0
    v_mov_b32 v102, 0
    v_mov_b32 v103, 0
    v_mov_b32 v104, 0
    v_mov_b32 v105, 0
    v_mov_b32 v106, 0
    v_mov_b32 v107, 0
    v_mov_b32 v108, 0
    v_mov_b32 v109, 0
    v_mov_b32 v110, 0
    v_mov_b32 v111, 0
    v_mov_b32 v112, 0
    v_mov_b32 v113, 0
    v_mov_b32 v114, 0
    v_mov_b32 v115, 0
    v_mov_b32 v116, 0
    v_mov_b32 v117, 0
    v_mov_b32 v118, 0
    v_mov_b32 v119, 0
    v_mov_b32 v120, 0
    v_mov_b32 v121, 0
    v_mov_b32 v122, 0
    v_mov_b32 v123, 0
    v_mov_b32 v124, 0
    v_mov_b32 v125, 0
    v_mov_b32 v126, 0
    v_mov_b32 v127, 0
    v_mov_b32 v128, 0
    v_mov_b32 v129, 0
    v_mov_b32 v130, 0
    v_mov_b32 v131, 0
    v_mov_b32 v132, 0
    v_mov_b32 v133, 0
    v_mov_b32 v134, 0
    v_mov_b32 v135, 0
    v_mov_b32 v136, 0
    v_mov_b32 v137, 0
    v_mov_b32 v138, 0
    v_mov_b32 v139, 0
    v_mov_b32 v140, 0
    v_mov_b32 v141, 0
    v_mov_b32 v142, 0
    v_mov_b32 v143, 0
    v_mov_b32 v144, 0
    v_mov_b32 v145, 0
    v_mov_b32 v146, 0
    v_mov_b32 v147, 0
    v_mov_b32 v148, 0
    v_mov_b32 v149, 0
    v_mov_b32 v150, 0
    v_mov_b32 v151, 0
    v_mov_b32 v152, 0
    v_mov_b32 v153, 0
    v_mov_b32 v154, 0
    v_mov_b32 v155, 0
    v_mov_b32 v156, 0
    v_mov_b32 v157, 0
    v_mov_b32 v158, 0
    v_mov_b32 v159, 0
    v_mov_b32 v160, 0
    v_mov_b32 v161, 0
    v_mov_b32 v162, 0
    v_mov_b32 v163, 0
    v_mov_b32 v164, 0
    v_mov_b32 v165, 0
    v_mov_b32 v166, 0
    v_mov_b32 v167, 0
    v_mov_b32 v168, 0
    v_mov_b32 v169, 0
    v_mov_b32 v170, 0
    v_mov_b32 v171, 0
    v_mov_b32 v172, 0
    v_mov_b32 v173, 0
    v_mov_b32 v174, 0
    v_mov_b32 v175, 0
    v_mov_b32 v176, 0
    v_mov_b32 v177, 0
    v_mov_b32 v178, 0
    v_mov_b32 v179, 0
    v_mov_b32 v180, 0
    v_mov_b32 v181, 0
    v_mov_b32 v182, 0
    v_mov_b32 v183, 0
    v_mov_b32 v184, 0
    v_mov_b32 v185, 0
    v_mov_b32 v186, 0
    v_mov_b32 v187, 0
    v_mov_b32 v188, 0
    v_mov_b32 v189, 0
    v_mov_b32 v190, 0
    v_mov_b32 v191, 0
    v_mov_b32 v192, 0
    v_mov_b32 v193, 0
    v_mov_b32 v194, 0
    v_mov_b32 v195, 0
    v_mov_b32 v196, 0
    v_mov_b32 v197, 0
    v_mov_b32 v198, 0
    v_mov_b32 v199, 0
    v_mov_b32 v200, 0
    v_mov_b32 v201, 0
    v_mov_b32 v202, 0
    v_mov_b32 v203, 0
    v_mov_b32 v204, 0
    v_mov_b32 v205, 0
    v_mov_b32 v206, 0
    v_mov_b32 v207, 0
    v_mov_b32 v208, 0
    v_mov_b32 v209, 0
    v_mov_b32 v210, 0
    v_mov_b32 v211, 0
    v_mov_b32 v212, 0
    v_mov_b32 v213, 0
    v_mov_b32 v214, 0
    v_mov_b32 v215, 0
    v_mov_b32 v216, 0
    v_mov_b32 v217, 0
    v_mov_b32 v218, 0
    v_mov_b32 v219, 0
    v_mov_b32 v220, 0
    v_mov_b32 v221, 0
    v_mov_b32 v222, 0
    v_mov_b32 v223, 0
    v_mov_b32 v224, 0
    v_mov_b32 v225, 0
    v_mov_b32 v226, 0
    v_mov_b32 v227, 0
    v_mov_b32 v228, 0
    v_mov_b32 v229, 0
    v_mov_b32 v230, 0
    v_mov_b32 v231, 0
    v_mov_b32 v232, 0
    v_mov_b32 v233, 0
    v_mov_b32 v234, 0
    v_mov_b32 v235, 0
    v_mov_b32 v236, 0
    v_mov_b32 v237, 0
    v_mov_b32 v238, 0
    v_mov_b32 v239, 0
    s_lshl_b32 s46, s45, 10
    s_mul_i32 s48, s45, 128
    s_mov_b64 s[50:51], 255
    s_mul_i32 s40, s47, 1152
    s_mul_i32 s41, s47, 5308416
    s_add_u32 m0, s46, 0
    s_nop 0
    buffer_load_dwordx4 v2, s[12:15], s40 offen lds
    s_add_u32 m0, s46, 8192
    s_nop 0
    buffer_load_dwordx4 v3, s[12:15], s40 offen lds
    s_add_u32 m0, s46, 16384
    s_nop 0
    buffer_load_dwordx4 v4, s[16:19], s41 offen lds
    s_add_u32 m0, s48, 24576
    s_mov_b64 exec, s[50:51]
    buffer_load_dwordx4 v5, s[16:19], s41 offen lds
    s_mov_b64 exec, -1
    s_add_u32 m0, s46, 25600
    s_nop 0
    buffer_load_dwordx4 v4, s[20:23], s41 offen lds
    s_add_u32 m0, s48, 33792
    s_mov_b64 exec, s[50:51]
    buffer_load_dwordx4 v5, s[20:23], s41 offen lds
    s_mov_b64 exec, -1
    s_add_u32 s40, s40, 64
    s_add_u32 s41, s41, 294912
    s_add_u32 m0, s46, 34816
    s_nop 0
    buffer_load_dwordx4 v2, s[12:15], s40 offen lds
    s_add_u32 m0, s46, 43008
    s_nop 0
    buffer_load_dwordx4 v3, s[12:15], s40 offen lds
    s_add_u32 m0, s46, 51200
    s_nop 0
    buffer_load_dwordx4 v4, s[16:19], s41 offen lds
    s_add_u32 m0, s48, 59392
    s_mov_b64 exec, s[50:51]
    buffer_load_dwordx4 v5, s[16:19], s41 offen lds
    s_mov_b64 exec, -1
    s_add_u32 m0, s46, 60416
    s_nop 0
    buffer_load_dwordx4 v4, s[20:23], s41 offen lds
    s_add_u32 m0, s48, 68608
    s_mov_b64 exec, s[50:51]
    buffer_load_dwordx4 v5, s[20:23], s41 offen lds
    s_mov_b64 exec, -1
    s_add_u32 s40, s40, 64
    s_add_u32 s41, s41, 294912
    s_mov_b32 s42, 6
gu_kernel_loop:
    s_waitcnt vmcnt(6)
    s_barrier
    ds_read_b128 v[16:19], v6 offset:0
    ds_read_b128 v[20:23], v6 offset:1024
    ds_read_b64_tr_b16 v[24:25], v7 offset:0
    ds_read_b64_tr_b16 v[26:27], v7 offset:1152
    ds_read_b64_tr_b16 v[28:29], v7 offset:32
    ds_read_b64_tr_b16 v[30:31], v7 offset:1184
    ds_read_b64_tr_b16 v[32:33], v7 offset:64
    ds_read_b64_tr_b16 v[34:35], v7 offset:1216
    ds_read_b64_tr_b16 v[36:37], v7 offset:96
    ds_read_b64_tr_b16 v[38:39], v7 offset:1248
    ds_read_b64_tr_b16 v[40:41], v7 offset:128
    ds_read_b64_tr_b16 v[42:43], v7 offset:1280
    ds_read_b64_tr_b16 v[44:45], v7 offset:160
    ds_read_b64_tr_b16 v[46:47], v7 offset:1312
    ds_read_b64_tr_b16 v[48:49], v7 offset:192
    ds_read_b64_tr_b16 v[50:51], v7 offset:1344
    ds_read_b64_tr_b16 v[52:53], v7 offset:224
    ds_read_b64_tr_b16 v[54:55], v7 offset:1376
    ds_read_b64_tr_b16 v[56:57], v7 offset:256
    ds_read_b64_tr_b16 v[58:59], v7 offset:1408
    ds_read_b64_tr_b16 v[60:61], v7 offset:9216
    ds_read_b64_tr_b16 v[62:63], v7 offset:10368
    ds_read_b64_tr_b16 v[64:65], v7 offset:9248
    ds_read_b64_tr_b16 v[66:67], v7 offset:10400
    ds_read_b64_tr_b16 v[68:69], v7 offset:9280
    ds_read_b64_tr_b16 v[70:71], v7 offset:10432
    ds_read_b64_tr_b16 v[72:73], v7 offset:9312
    ds_read_b64_tr_b16 v[74:75], v7 offset:10464
    ds_read_b64_tr_b16 v[76:77], v7 offset:9344
    ds_read_b64_tr_b16 v[78:79], v7 offset:10496
    ds_read_b64_tr_b16 v[80:81], v7 offset:9376
    ds_read_b64_tr_b16 v[82:83], v7 offset:10528
    ds_read_b64_tr_b16 v[84:85], v7 offset:9408
    ds_read_b64_tr_b16 v[86:87], v7 offset:10560
    ds_read_b64_tr_b16 v[88:89], v7 offset:9440
    ds_read_b64_tr_b16 v[90:91], v7 offset:10592
    ds_read_b64_tr_b16 v[92:93], v7 offset:9472
    ds_read_b64_tr_b16 v[94:95], v7 offset:10624
    s_add_u32 m0, s46, 69632
    s_nop 0
    buffer_load_dwordx4 v2, s[12:15], s40 offen lds
    s_add_u32 m0, s46, 77824
    s_nop 0
    buffer_load_dwordx4 v3, s[12:15], s40 offen lds
    s_add_u32 m0, s46, 86016
    s_nop 0
    buffer_load_dwordx4 v4, s[16:19], s41 offen lds
    s_add_u32 m0, s48, 94208
    s_mov_b64 exec, s[50:51]
    buffer_load_dwordx4 v5, s[16:19], s41 offen lds
    s_mov_b64 exec, -1
    s_add_u32 m0, s46, 95232
    s_nop 0
    buffer_load_dwordx4 v4, s[20:23], s41 offen lds
    s_add_u32 m0, s48, 103424
    s_mov_b64 exec, s[50:51]
    buffer_load_dwordx4 v5, s[20:23], s41 offen lds
    s_mov_b64 exec, -1
    s_add_u32 s40, s40, 64
    s_add_u32 s41, s41, 294912
    s_waitcnt lgkmcnt(15)
    v_mfma_f32_16x16x32_bf16 v[96:99], v[24:27], v[16:19], v[96:99]
    v_mfma_f32_16x16x32_bf16 v[132:135], v[24:27], v[20:23], v[132:135]
    s_waitcnt lgkmcnt(15)
    v_mfma_f32_16x16x32_bf16 v[100:103], v[28:31], v[16:19], v[100:103]
    v_mfma_f32_16x16x32_bf16 v[136:139], v[28:31], v[20:23], v[136:139]
    s_waitcnt lgkmcnt(15)
    v_mfma_f32_16x16x32_bf16 v[104:107], v[32:35], v[16:19], v[104:107]
    v_mfma_f32_16x16x32_bf16 v[140:143], v[32:35], v[20:23], v[140:143]
    s_waitcnt lgkmcnt(15)
    v_mfma_f32_16x16x32_bf16 v[108:111], v[36:39], v[16:19], v[108:111]
    v_mfma_f32_16x16x32_bf16 v[144:147], v[36:39], v[20:23], v[144:147]
    s_waitcnt lgkmcnt(15)
    v_mfma_f32_16x16x32_bf16 v[112:115], v[40:43], v[16:19], v[112:115]
    v_mfma_f32_16x16x32_bf16 v[148:151], v[40:43], v[20:23], v[148:151]
    s_waitcnt lgkmcnt(15)
    v_mfma_f32_16x16x32_bf16 v[116:119], v[44:47], v[16:19], v[116:119]
    v_mfma_f32_16x16x32_bf16 v[152:155], v[44:47], v[20:23], v[152:155]
    s_waitcnt lgkmcnt(15)
    v_mfma_f32_16x16x32_bf16 v[120:123], v[48:51], v[16:19], v[120:123]
    v_mfma_f32_16x16x32_bf16 v[156:159], v[48:51], v[20:23], v[156:159]
    s_waitcnt lgkmcnt(15)
    v_mfma_f32_16x16x32_bf16 v[124:127], v[52:55], v[16:19], v[124:127]
    v_mfma_f32_16x16x32_bf16 v[160:163], v[52:55], v[20:23], v[160:163]
    s_waitcnt lgkmcnt(15)
    v_mfma_f32_16x16x32_bf16 v[128:131], v[56:59], v[16:19], v[128:131]
    v_mfma_f32_16x16x32_bf16 v[164:167], v[56:59], v[20:23], v[164:167]
    s_waitcnt lgkmcnt(15)
    v_mfma_f32_16x16x32_bf16 v[168:171], v[60:63], v[16:19], v[168:171]
    v_mfma_f32_16x16x32_bf16 v[204:207], v[60:63], v[20:23], v[204:207]
    s_waitcnt lgkmcnt(14)
    v_mfma_f32_16x16x32_bf16 v[172:175], v[64:67], v[16:19], v[172:175]
    v_mfma_f32_16x16x32_bf16 v[208:211], v[64:67], v[20:23], v[208:211]
    s_waitcnt lgkmcnt(12)
    v_mfma_f32_16x16x32_bf16 v[176:179], v[68:71], v[16:19], v[176:179]
    v_mfma_f32_16x16x32_bf16 v[212:215], v[68:71], v[20:23], v[212:215]
    s_waitcnt lgkmcnt(10)
    v_mfma_f32_16x16x32_bf16 v[180:183], v[72:75], v[16:19], v[180:183]
    v_mfma_f32_16x16x32_bf16 v[216:219], v[72:75], v[20:23], v[216:219]
    s_waitcnt lgkmcnt(8)
    v_mfma_f32_16x16x32_bf16 v[184:187], v[76:79], v[16:19], v[184:187]
    v_mfma_f32_16x16x32_bf16 v[220:223], v[76:79], v[20:23], v[220:223]
    s_waitcnt lgkmcnt(6)
    v_mfma_f32_16x16x32_bf16 v[188:191], v[80:83], v[16:19], v[188:191]
    v_mfma_f32_16x16x32_bf16 v[224:227], v[80:83], v[20:23], v[224:227]
    s_waitcnt lgkmcnt(4)
    v_mfma_f32_16x16x32_bf16 v[192:195], v[84:87], v[16:19], v[192:195]
    v_mfma_f32_16x16x32_bf16 v[228:231], v[84:87], v[20:23], v[228:231]
    s_waitcnt lgkmcnt(2)
    v_mfma_f32_16x16x32_bf16 v[196:199], v[88:91], v[16:19], v[196:199]
    v_mfma_f32_16x16x32_bf16 v[232:235], v[88:91], v[20:23], v[232:235]
    s_waitcnt lgkmcnt(0)
    v_mfma_f32_16x16x32_bf16 v[200:203], v[92:95], v[16:19], v[200:203]
    v_mfma_f32_16x16x32_bf16 v[236:239], v[92:95], v[20:23], v[236:239]
    s_waitcnt vmcnt(6)
    s_barrier
    ds_read_b128 v[16:19], v6 offset:34816
    ds_read_b128 v[20:23], v6 offset:35840
    ds_read_b64_tr_b16 v[24:25], v7 offset:34816
    ds_read_b64_tr_b16 v[26:27], v7 offset:35968
    ds_read_b64_tr_b16 v[28:29], v7 offset:34848
    ds_read_b64_tr_b16 v[30:31], v7 offset:36000
    ds_read_b64_tr_b16 v[32:33], v7 offset:34880
    ds_read_b64_tr_b16 v[34:35], v7 offset:36032
    ds_read_b64_tr_b16 v[36:37], v7 offset:34912
    ds_read_b64_tr_b16 v[38:39], v7 offset:36064
    ds_read_b64_tr_b16 v[40:41], v7 offset:34944
    ds_read_b64_tr_b16 v[42:43], v7 offset:36096
    ds_read_b64_tr_b16 v[44:45], v7 offset:34976
    ds_read_b64_tr_b16 v[46:47], v7 offset:36128
    ds_read_b64_tr_b16 v[48:49], v7 offset:35008
    ds_read_b64_tr_b16 v[50:51], v7 offset:36160
    ds_read_b64_tr_b16 v[52:53], v7 offset:35040
    ds_read_b64_tr_b16 v[54:55], v7 offset:36192
    ds_read_b64_tr_b16 v[56:57], v7 offset:35072
    ds_read_b64_tr_b16 v[58:59], v7 offset:36224
    ds_read_b64_tr_b16 v[60:61], v7 offset:44032
    ds_read_b64_tr_b16 v[62:63], v7 offset:45184
    ds_read_b64_tr_b16 v[64:65], v7 offset:44064
    ds_read_b64_tr_b16 v[66:67], v7 offset:45216
    ds_read_b64_tr_b16 v[68:69], v7 offset:44096
    ds_read_b64_tr_b16 v[70:71], v7 offset:45248
    ds_read_b64_tr_b16 v[72:73], v7 offset:44128
    ds_read_b64_tr_b16 v[74:75], v7 offset:45280
    ds_read_b64_tr_b16 v[76:77], v7 offset:44160
    ds_read_b64_tr_b16 v[78:79], v7 offset:45312
    ds_read_b64_tr_b16 v[80:81], v7 offset:44192
    ds_read_b64_tr_b16 v[82:83], v7 offset:45344
    ds_read_b64_tr_b16 v[84:85], v7 offset:44224
    ds_read_b64_tr_b16 v[86:87], v7 offset:45376
    ds_read_b64_tr_b16 v[88:89], v7 offset:44256
    ds_read_b64_tr_b16 v[90:91], v7 offset:45408
    ds_read_b64_tr_b16 v[92:93], v7 offset:44288
    ds_read_b64_tr_b16 v[94:95], v7 offset:45440
    s_add_u32 m0, s46, 0
    s_nop 0
    buffer_load_dwordx4 v2, s[12:15], s40 offen lds
    s_add_u32 m0, s46, 8192
    s_nop 0
    buffer_load_dwordx4 v3, s[12:15], s40 offen lds
    s_add_u32 m0, s46, 16384
    s_nop 0
    buffer_load_dwordx4 v4, s[16:19], s41 offen lds
    s_add_u32 m0, s48, 24576
    s_mov_b64 exec, s[50:51]
    buffer_load_dwordx4 v5, s[16:19], s41 offen lds
    s_mov_b64 exec, -1
    s_add_u32 m0, s46, 25600
    s_nop 0
    buffer_load_dwordx4 v4, s[20:23], s41 offen lds
    s_add_u32 m0, s48, 33792
    s_mov_b64 exec, s[50:51]
    buffer_load_dwordx4 v5, s[20:23], s41 offen lds
    s_mov_b64 exec, -1
    s_add_u32 s40, s40, 64
    s_add_u32 s41, s41, 294912
    s_waitcnt lgkmcnt(15)
    v_mfma_f32_16x16x32_bf16 v[96:99], v[24:27], v[16:19], v[96:99]
    v_mfma_f32_16x16x32_bf16 v[132:135], v[24:27], v[20:23], v[132:135]
    s_waitcnt lgkmcnt(15)
    v_mfma_f32_16x16x32_bf16 v[100:103], v[28:31], v[16:19], v[100:103]
    v_mfma_f32_16x16x32_bf16 v[136:139], v[28:31], v[20:23], v[136:139]
    s_waitcnt lgkmcnt(15)
    v_mfma_f32_16x16x32_bf16 v[104:107], v[32:35], v[16:19], v[104:107]
    v_mfma_f32_16x16x32_bf16 v[140:143], v[32:35], v[20:23], v[140:143]
    s_waitcnt lgkmcnt(15)
    v_mfma_f32_16x16x32_bf16 v[108:111], v[36:39], v[16:19], v[108:111]
    v_mfma_f32_16x16x32_bf16 v[144:147], v[36:39], v[20:23], v[144:147]
    s_waitcnt lgkmcnt(15)
    v_mfma_f32_16x16x32_bf16 v[112:115], v[40:43], v[16:19], v[112:115]
    v_mfma_f32_16x16x32_bf16 v[148:151], v[40:43], v[20:23], v[148:151]
    s_waitcnt lgkmcnt(15)
    v_mfma_f32_16x16x32_bf16 v[116:119], v[44:47], v[16:19], v[116:119]
    v_mfma_f32_16x16x32_bf16 v[152:155], v[44:47], v[20:23], v[152:155]
    s_waitcnt lgkmcnt(15)
    v_mfma_f32_16x16x32_bf16 v[120:123], v[48:51], v[16:19], v[120:123]
    v_mfma_f32_16x16x32_bf16 v[156:159], v[48:51], v[20:23], v[156:159]
    s_waitcnt lgkmcnt(15)
    v_mfma_f32_16x16x32_bf16 v[124:127], v[52:55], v[16:19], v[124:127]
    v_mfma_f32_16x16x32_bf16 v[160:163], v[52:55], v[20:23], v[160:163]
    s_waitcnt lgkmcnt(15)
    v_mfma_f32_16x16x32_bf16 v[128:131], v[56:59], v[16:19], v[128:131]
    v_mfma_f32_16x16x32_bf16 v[164:167], v[56:59], v[20:23], v[164:167]
    s_waitcnt lgkmcnt(15)
    v_mfma_f32_16x16x32_bf16 v[168:171], v[60:63], v[16:19], v[168:171]
    v_mfma_f32_16x16x32_bf16 v[204:207], v[60:63], v[20:23], v[204:207]
    s_waitcnt lgkmcnt(14)
    v_mfma_f32_16x16x32_bf16 v[172:175], v[64:67], v[16:19], v[172:175]
    v_mfma_f32_16x16x32_bf16 v[208:211], v[64:67], v[20:23], v[208:211]
    s_waitcnt lgkmcnt(12)
    v_mfma_f32_16x16x32_bf16 v[176:179], v[68:71], v[16:19], v[176:179]
    v_mfma_f32_16x16x32_bf16 v[212:215], v[68:71], v[20:23], v[212:215]
    s_waitcnt lgkmcnt(10)
    v_mfma_f32_16x16x32_bf16 v[180:183], v[72:75], v[16:19], v[180:183]
    v_mfma_f32_16x16x32_bf16 v[216:219], v[72:75], v[20:23], v[216:219]
    s_waitcnt lgkmcnt(8)
    v_mfma_f32_16x16x32_bf16 v[184:187], v[76:79], v[16:19], v[184:187]
    v_mfma_f32_16x16x32_bf16 v[220:223], v[76:79], v[20:23], v[220:223]
    s_waitcnt lgkmcnt(6)
    v_mfma_f32_16x16x32_bf16 v[188:191], v[80:83], v[16:19], v[188:191]
    v_mfma_f32_16x16x32_bf16 v[224:227], v[80:83], v[20:23], v[224:227]
    s_waitcnt lgkmcnt(4)
    v_mfma_f32_16x16x32_bf16 v[192:195], v[84:87], v[16:19], v[192:195]
    v_mfma_f32_16x16x32_bf16 v[228:231], v[84:87], v[20:23], v[228:231]
    s_waitcnt lgkmcnt(2)
    v_mfma_f32_16x16x32_bf16 v[196:199], v[88:91], v[16:19], v[196:199]
    v_mfma_f32_16x16x32_bf16 v[232:235], v[88:91], v[20:23], v[232:235]
    s_waitcnt lgkmcnt(0)
    v_mfma_f32_16x16x32_bf16 v[200:203], v[92:95], v[16:19], v[200:203]
    v_mfma_f32_16x16x32_bf16 v[236:239], v[92:95], v[20:23], v[236:239]
    s_waitcnt vmcnt(6)
    s_barrier
    ds_read_b128 v[16:19], v8 offset:4096
    ds_read_b128 v[20:23], v8 offset:5120
    ds_read_b64_tr_b16 v[24:25], v9 offset:4096
    ds_read_b64_tr_b16 v[26:27], v9 offset:5248
    ds_read_b64_tr_b16 v[28:29], v9 offset:4128
    ds_read_b64_tr_b16 v[30:31], v9 offset:5280
    ds_read_b64_tr_b16 v[32:33], v9 offset:4160
    ds_read_b64_tr_b16 v[34:35], v9 offset:5312
    ds_read_b64_tr_b16 v[36:37], v9 offset:4192
    ds_read_b64_tr_b16 v[38:39], v9 offset:5344
    ds_read_b64_tr_b16 v[40:41], v9 offset:4224
    ds_read_b64_tr_b16 v[42:43], v9 offset:5376
    ds_read_b64_tr_b16 v[44:45], v9 offset:4256
    ds_read_b64_tr_b16 v[46:47], v9 offset:5408
    ds_read_b64_tr_b16 v[48:49], v9 offset:4288
    ds_read_b64_tr_b16 v[50:51], v9 offset:5440
    ds_read_b64_tr_b16 v[52:53], v9 offset:4320
    ds_read_b64_tr_b16 v[54:55], v9 offset:5472
    ds_read_b64_tr_b16 v[56:57], v9 offset:4352
    ds_read_b64_tr_b16 v[58:59], v9 offset:5504
    ds_read_b64_tr_b16 v[60:61], v9 offset:13312
    ds_read_b64_tr_b16 v[62:63], v9 offset:14464
    ds_read_b64_tr_b16 v[64:65], v9 offset:13344
    ds_read_b64_tr_b16 v[66:67], v9 offset:14496
    ds_read_b64_tr_b16 v[68:69], v9 offset:13376
    ds_read_b64_tr_b16 v[70:71], v9 offset:14528
    ds_read_b64_tr_b16 v[72:73], v9 offset:13408
    ds_read_b64_tr_b16 v[74:75], v9 offset:14560
    ds_read_b64_tr_b16 v[76:77], v9 offset:13440
    ds_read_b64_tr_b16 v[78:79], v9 offset:14592
    ds_read_b64_tr_b16 v[80:81], v9 offset:13472
    ds_read_b64_tr_b16 v[82:83], v9 offset:14624
    ds_read_b64_tr_b16 v[84:85], v9 offset:13504
    ds_read_b64_tr_b16 v[86:87], v9 offset:14656
    ds_read_b64_tr_b16 v[88:89], v9 offset:13536
    ds_read_b64_tr_b16 v[90:91], v9 offset:14688
    ds_read_b64_tr_b16 v[92:93], v9 offset:13568
    ds_read_b64_tr_b16 v[94:95], v9 offset:14720
    s_add_u32 m0, s46, 34816
    s_nop 0
    buffer_load_dwordx4 v2, s[12:15], s40 offen lds
    s_add_u32 m0, s46, 43008
    s_nop 0
    buffer_load_dwordx4 v3, s[12:15], s40 offen lds
    s_add_u32 m0, s46, 51200
    s_nop 0
    buffer_load_dwordx4 v4, s[16:19], s41 offen lds
    s_add_u32 m0, s48, 59392
    s_mov_b64 exec, s[50:51]
    buffer_load_dwordx4 v5, s[16:19], s41 offen lds
    s_mov_b64 exec, -1
    s_add_u32 m0, s46, 60416
    s_nop 0
    buffer_load_dwordx4 v4, s[20:23], s41 offen lds
    s_add_u32 m0, s48, 68608
    s_mov_b64 exec, s[50:51]
    buffer_load_dwordx4 v5, s[20:23], s41 offen lds
    s_mov_b64 exec, -1
    s_add_u32 s40, s40, 64
    s_add_u32 s41, s41, 294912
    s_waitcnt lgkmcnt(15)
    v_mfma_f32_16x16x32_bf16 v[96:99], v[24:27], v[16:19], v[96:99]
    v_mfma_f32_16x16x32_bf16 v[132:135], v[24:27], v[20:23], v[132:135]
    s_waitcnt lgkmcnt(15)
    v_mfma_f32_16x16x32_bf16 v[100:103], v[28:31], v[16:19], v[100:103]
    v_mfma_f32_16x16x32_bf16 v[136:139], v[28:31], v[20:23], v[136:139]
    s_waitcnt lgkmcnt(15)
    v_mfma_f32_16x16x32_bf16 v[104:107], v[32:35], v[16:19], v[104:107]
    v_mfma_f32_16x16x32_bf16 v[140:143], v[32:35], v[20:23], v[140:143]
    s_waitcnt lgkmcnt(15)
    v_mfma_f32_16x16x32_bf16 v[108:111], v[36:39], v[16:19], v[108:111]
    v_mfma_f32_16x16x32_bf16 v[144:147], v[36:39], v[20:23], v[144:147]
    s_waitcnt lgkmcnt(15)
    v_mfma_f32_16x16x32_bf16 v[112:115], v[40:43], v[16:19], v[112:115]
    v_mfma_f32_16x16x32_bf16 v[148:151], v[40:43], v[20:23], v[148:151]
    s_waitcnt lgkmcnt(15)
    v_mfma_f32_16x16x32_bf16 v[116:119], v[44:47], v[16:19], v[116:119]
    v_mfma_f32_16x16x32_bf16 v[152:155], v[44:47], v[20:23], v[152:155]
    s_waitcnt lgkmcnt(15)
    v_mfma_f32_16x16x32_bf16 v[120:123], v[48:51], v[16:19], v[120:123]
    v_mfma_f32_16x16x32_bf16 v[156:159], v[48:51], v[20:23], v[156:159]
    s_waitcnt lgkmcnt(15)
    v_mfma_f32_16x16x32_bf16 v[124:127], v[52:55], v[16:19], v[124:127]
    v_mfma_f32_16x16x32_bf16 v[160:163], v[52:55], v[20:23], v[160:163]
    s_waitcnt lgkmcnt(15)
    v_mfma_f32_16x16x32_bf16 v[128:131], v[56:59], v[16:19], v[128:131]
    v_mfma_f32_16x16x32_bf16 v[164:167], v[56:59], v[20:23], v[164:167]
    s_waitcnt lgkmcnt(15)
    v_mfma_f32_16x16x32_bf16 v[168:171], v[60:63], v[16:19], v[168:171]
    v_mfma_f32_16x16x32_bf16 v[204:207], v[60:63], v[20:23], v[204:207]
    s_waitcnt lgkmcnt(14)
    v_mfma_f32_16x16x32_bf16 v[172:175], v[64:67], v[16:19], v[172:175]
    v_mfma_f32_16x16x32_bf16 v[208:211], v[64:67], v[20:23], v[208:211]
    s_waitcnt lgkmcnt(12)
    v_mfma_f32_16x16x32_bf16 v[176:179], v[68:71], v[16:19], v[176:179]
    v_mfma_f32_16x16x32_bf16 v[212:215], v[68:71], v[20:23], v[212:215]
    s_waitcnt lgkmcnt(10)
    v_mfma_f32_16x16x32_bf16 v[180:183], v[72:75], v[16:19], v[180:183]
    v_mfma_f32_16x16x32_bf16 v[216:219], v[72:75], v[20:23], v[216:219]
    s_waitcnt lgkmcnt(8)
    v_mfma_f32_16x16x32_bf16 v[184:187], v[76:79], v[16:19], v[184:187]
    v_mfma_f32_16x16x32_bf16 v[220:223], v[76:79], v[20:23], v[220:223]
    s_waitcnt lgkmcnt(6)
    v_mfma_f32_16x16x32_bf16 v[188:191], v[80:83], v[16:19], v[188:191]
    v_mfma_f32_16x16x32_bf16 v[224:227], v[80:83], v[20:23], v[224:227]
    s_waitcnt lgkmcnt(4)
    v_mfma_f32_16x16x32_bf16 v[192:195], v[84:87], v[16:19], v[192:195]
    v_mfma_f32_16x16x32_bf16 v[228:231], v[84:87], v[20:23], v[228:231]
    s_waitcnt lgkmcnt(2)
    v_mfma_f32_16x16x32_bf16 v[196:199], v[88:91], v[16:19], v[196:199]
    v_mfma_f32_16x16x32_bf16 v[232:235], v[88:91], v[20:23], v[232:235]
    s_waitcnt lgkmcnt(0)
    v_mfma_f32_16x16x32_bf16 v[200:203], v[92:95], v[16:19], v[200:203]
    v_mfma_f32_16x16x32_bf16 v[236:239], v[92:95], v[20:23], v[236:239]
    s_sub_u32 s42, s42, 1
    s_cmp_lg_u32 s42, 0
    s_cbranch_scc1 gu_kernel_loop
    s_waitcnt vmcnt(0)
    s_nop 15
    v_and_b32 v18, 15, v1
    v_lshrrev_b32 v19, 4, v1
    v_mul_u32_u24 v20, 32, v15
    v_add3_u32 v20, v20, v18, s33
    v_lshl_add_u32 v21, v19, 2, s34

    s_add_u32 s28, s8, 33554432
    s_addc_u32 s29, s9, 0
    s_mov_b32 s30, 18874368
    s_mov_b32 s31, 0x00020000
    v_add_u32 v23, 0, v20
    v_mul_u32_u24 v24, 9216, v23
    v_lshl_add_u32 v24, v21, 1, v24
    v_mul_f32 v32, v96, v168
    v_mul_f32 v33, v97, v169
    v_mul_f32 v34, v98, v170
    v_mul_f32 v35, v99, v171
    v_cvt_pk_bf16_f32 v26, v32, v33
    v_cvt_pk_bf16_f32 v27, v34, v35
    buffer_store_dwordx2 v[26:27], v24, s[28:31], 0 offen offset:0
    s_nop 0
    v_mul_f32 v32, v100, v172
    v_mul_f32 v33, v101, v173
    v_mul_f32 v34, v102, v174
    v_mul_f32 v35, v103, v175
    v_cvt_pk_bf16_f32 v26, v32, v33
    v_cvt_pk_bf16_f32 v27, v34, v35
    buffer_store_dwordx2 v[26:27], v24, s[28:31], 0 offen offset:32
    s_nop 0
    v_mul_f32 v32, v104, v176
    v_mul_f32 v33, v105, v177
    v_mul_f32 v34, v106, v178
    v_mul_f32 v35, v107, v179
    v_cvt_pk_bf16_f32 v26, v32, v33
    v_cvt_pk_bf16_f32 v27, v34, v35
    buffer_store_dwordx2 v[26:27], v24, s[28:31], 0 offen offset:64
    s_nop 0
    v_mul_f32 v32, v108, v180
    v_mul_f32 v33, v109, v181
    v_mul_f32 v34, v110, v182
    v_mul_f32 v35, v111, v183
    v_cvt_pk_bf16_f32 v26, v32, v33
    v_cvt_pk_bf16_f32 v27, v34, v35
    buffer_store_dwordx2 v[26:27], v24, s[28:31], 0 offen offset:96
    s_nop 0
    v_mul_f32 v32, v112, v184
    v_mul_f32 v33, v113, v185
    v_mul_f32 v34, v114, v186
    v_mul_f32 v35, v115, v187
    v_cvt_pk_bf16_f32 v26, v32, v33
    v_cvt_pk_bf16_f32 v27, v34, v35
    buffer_store_dwordx2 v[26:27], v24, s[28:31], 0 offen offset:128
    s_nop 0
    v_mul_f32 v32, v116, v188
    v_mul_f32 v33, v117, v189
    v_mul_f32 v34, v118, v190
    v_mul_f32 v35, v119, v191
    v_cvt_pk_bf16_f32 v26, v32, v33
    v_cvt_pk_bf16_f32 v27, v34, v35
    buffer_store_dwordx2 v[26:27], v24, s[28:31], 0 offen offset:160
    s_nop 0
    v_mul_f32 v32, v120, v192
    v_mul_f32 v33, v121, v193
    v_mul_f32 v34, v122, v194
    v_mul_f32 v35, v123, v195
    v_cvt_pk_bf16_f32 v26, v32, v33
    v_cvt_pk_bf16_f32 v27, v34, v35
    buffer_store_dwordx2 v[26:27], v24, s[28:31], 0 offen offset:192
    s_nop 0
    v_mul_f32 v32, v124, v196
    v_mul_f32 v33, v125, v197
    v_mul_f32 v34, v126, v198
    v_mul_f32 v35, v127, v199
    v_cvt_pk_bf16_f32 v26, v32, v33
    v_cvt_pk_bf16_f32 v27, v34, v35
    buffer_store_dwordx2 v[26:27], v24, s[28:31], 0 offen offset:224
    s_nop 0
    v_mul_f32 v32, v128, v200
    v_mul_f32 v33, v129, v201
    v_mul_f32 v34, v130, v202
    v_mul_f32 v35, v131, v203
    v_cvt_pk_bf16_f32 v26, v32, v33
    v_cvt_pk_bf16_f32 v27, v34, v35
    buffer_store_dwordx2 v[26:27], v24, s[28:31], 0 offen offset:256
    s_nop 0
    v_add_u32 v23, 16, v20
    v_mul_u32_u24 v24, 9216, v23
    v_lshl_add_u32 v24, v21, 1, v24
    v_mul_f32 v32, v132, v204
    v_mul_f32 v33, v133, v205
    v_mul_f32 v34, v134, v206
    v_mul_f32 v35, v135, v207
    v_cvt_pk_bf16_f32 v26, v32, v33
    v_cvt_pk_bf16_f32 v27, v34, v35
    buffer_store_dwordx2 v[26:27], v24, s[28:31], 0 offen offset:0
    s_nop 0
    v_mul_f32 v32, v136, v208
    v_mul_f32 v33, v137, v209
    v_mul_f32 v34, v138, v210
    v_mul_f32 v35, v139, v211
    v_cvt_pk_bf16_f32 v26, v32, v33
    v_cvt_pk_bf16_f32 v27, v34, v35
    buffer_store_dwordx2 v[26:27], v24, s[28:31], 0 offen offset:32
    s_nop 0
    v_mul_f32 v32, v140, v212
    v_mul_f32 v33, v141, v213
    v_mul_f32 v34, v142, v214
    v_mul_f32 v35, v143, v215
    v_cvt_pk_bf16_f32 v26, v32, v33
    v_cvt_pk_bf16_f32 v27, v34, v35
    buffer_store_dwordx2 v[26:27], v24, s[28:31], 0 offen offset:64
    s_nop 0
    v_mul_f32 v32, v144, v216
    v_mul_f32 v33, v145, v217
    v_mul_f32 v34, v146, v218
    v_mul_f32 v35, v147, v219
    v_cvt_pk_bf16_f32 v26, v32, v33
    v_cvt_pk_bf16_f32 v27, v34, v35
    buffer_store_dwordx2 v[26:27], v24, s[28:31], 0 offen offset:96
    s_nop 0
    v_mul_f32 v32, v148, v220
    v_mul_f32 v33, v149, v221
    v_mul_f32 v34, v150, v222
    v_mul_f32 v35, v151, v223
    v_cvt_pk_bf16_f32 v26, v32, v33
    v_cvt_pk_bf16_f32 v27, v34, v35
    buffer_store_dwordx2 v[26:27], v24, s[28:31], 0 offen offset:128
    s_nop 0
    v_mul_f32 v32, v152, v224
    v_mul_f32 v33, v153, v225
    v_mul_f32 v34, v154, v226
    v_mul_f32 v35, v155, v227
    v_cvt_pk_bf16_f32 v26, v32, v33
    v_cvt_pk_bf16_f32 v27, v34, v35
    buffer_store_dwordx2 v[26:27], v24, s[28:31], 0 offen offset:160
    s_nop 0
    v_mul_f32 v32, v156, v228
    v_mul_f32 v33, v157, v229
    v_mul_f32 v34, v158, v230
    v_mul_f32 v35, v159, v231
    v_cvt_pk_bf16_f32 v26, v32, v33
    v_cvt_pk_bf16_f32 v27, v34, v35
    buffer_store_dwordx2 v[26:27], v24, s[28:31], 0 offen offset:192
    s_nop 0
    v_mul_f32 v32, v160, v232
    v_mul_f32 v33, v161, v233
    v_mul_f32 v34, v162, v234
    v_mul_f32 v35, v163, v235
    v_cvt_pk_bf16_f32 v26, v32, v33
    v_cvt_pk_bf16_f32 v27, v34, v35
    buffer_store_dwordx2 v[26:27], v24, s[28:31], 0 offen offset:224
    s_nop 0
    v_mul_f32 v32, v164, v236
    v_mul_f32 v33, v165, v237
    v_mul_f32 v34, v166, v238
    v_mul_f32 v35, v167, v239
    v_cvt_pk_bf16_f32 v26, v32, v33
    v_cvt_pk_bf16_f32 v27, v34, v35
    buffer_store_dwordx2 v[26:27], v24, s[28:31], 0 offen offset:256
    s_nop 0
gu_kernel_done:
    s_endpgm

.globl down_kernel
.p2align 8
.type down_kernel,@function
down_kernel:
    s_cmp_ge_u32 s2, 288
    s_cbranch_scc1 down_kernel_done
    s_load_dwordx2 s[8:9], s[0:1], 88

    s_load_dwordx2 s[36:37], s[0:1], 48
    s_load_dwordx2 s[6:7], s[0:1], 72
    s_waitcnt lgkmcnt(0)
    s_add_u32 s12, s8, 33554432
    s_addc_u32 s13, s9, 0
    s_mov_b32 s14, 18874368
    s_mov_b32 s15, 0x00020000
    s_mov_b32 s16, s36
    s_mov_b32 s17, s37
    s_mov_b32 s18, 5308416
    s_mov_b32 s19, 0x00020000
    s_and_b32 s29, s2, 7
    s_mul_i32 s29, s29, 36
    s_lshr_b32 s30, s2, 3
    s_add_u32 s29, s29, s30
    s_mov_b32 s30, 477218589
    s_mul_hi_u32 s31, s29, s30
    s_mul_i32 s32, s31, 9
    s_sub_u32 s32, s29, s32

    s_mul_i32 s33, s31, 64
    s_mul_i32 s34, s32, 64
    v_and_b32 v1, 63, v0
    v_lshrrev_b32 v15, 6, v0
    s_nop 1
    v_readfirstlane_b32 s45, v15
    v_lshrrev_b32 v48, 2, v1
    v_and_b32 v49, 3, v1
    v_lshrrev_b32 v50, 4, v1
    v_xor_b32 v49, v49, v50
    v_lshl_add_u32 v51, v15, 4, v48
    v_add_u32 v51, s33, v51
    v_mov_b32 v52, 9216

    v_add_u32 v53, 0, v51
    v_mul_lo_u32 v2, v53, v52
    v_lshl_add_u32 v2, v49, 4, v2
    v_lshrrev_b32 v48, 3, v1
    v_and_b32 v49, 7, v1
    v_lshrrev_b32 v50, 4, v1
    v_and_b32 v50, 1, v50
    v_lshlrev_b32 v50, 2, v50
    v_xor_b32 v49, v49, v50
    v_lshl_add_u32 v51, v15, 3, v48

    v_mov_b32 v52, 1152
    s_lshl_b32 s35, s34, 1
    v_add_u32 v53, 0, v51
    v_mul_lo_u32 v3, v53, v52
    v_lshl_add_u32 v3, v49, 4, v3
    v_add_u32 v3, s35, v3
    v_lshrrev_b32 v48, 1, v15
    v_and_b32 v49, 1, v15
    v_and_b32 v50, 31, v1
    v_lshrrev_b32 v51, 5, v1
    v_mul_u32_u24 v52, 32, v48
    v_add_u32 v52, v52, v50
    v_lshlrev_b32 v52, 6, v52
    v_lshrrev_b32 v53, 2, v50
    v_and_b32 v53, 3, v53
    v_xor_b32 v54, v51, v53
    v_lshl_add_u32 v4, v54, 4, v52
    v_xor_b32 v54, 2, v54
    v_lshl_add_u32 v5, v54, 4, v52

    v_and_b32 v53, 15, v1
    v_lshrrev_b32 v54, 2, v53
    v_lshl_add_u32 v55, v51, 3, v54
    v_mul_u32_u24 v55, 128, v55
    v_and_b32 v56, 3, v53
    v_and_b32 v57, 1, v56
    v_lshl_add_u32 v55, v57, 3, v55
    v_add_u32 v55, 4096, v55
    v_lshrrev_b32 v56, 1, v56
    v_lshrrev_b32 v57, 4, v1
    v_and_b32 v57, 1, v57
    v_lshl_add_u32 v56, v57, 1, v56
    v_lshl_add_u32 v56, v49, 2, v56

    v_lshrrev_b32 v57, 1, v54
    v_lshlrev_b32 v57, 2, v57
    v_add_u32 v58, 0, v56
    v_xor_b32 v58, v58, v57
    v_lshl_add_u32 v6, v58, 4, v55
    v_add_u32 v7, 0x10000, v4
    v_add_u32 v8, 0x10000, v5
    v_add_u32 v9, 0x10000, v6
    v_mov_b32 v32, 0
    v_mov_b32 v33, 0
    v_mov_b32 v34, 0
    v_mov_b32 v35, 0
    v_mov_b32 v36, 0
    v_mov_b32 v37, 0
    v_mov_b32 v38, 0
    v_mov_b32 v39, 0
    v_mov_b32 v40, 0
    v_mov_b32 v41, 0
    v_mov_b32 v42, 0
    v_mov_b32 v43, 0
    v_mov_b32 v44, 0
    v_mov_b32 v45, 0
    v_mov_b32 v46, 0
    v_mov_b32 v47, 0
    s_lshl_b32 s46, s45, 10
    s_mov_b32 s40, 0
    s_mov_b32 s41, 0
    s_add_u32 m0, s46, 0
    s_nop 0
    buffer_load_dwordx4 v2, s[12:15], s40 offen lds
    s_add_u32 m0, s46, 4096
    s_nop 0
    buffer_load_dwordx4 v3, s[16:19], s41 offen lds
    s_add_u32 s40, s40, 64
    s_add_u32 s41, s41, 36864
    s_add_u32 m0, s46, 8192
    s_nop 0
    buffer_load_dwordx4 v2, s[12:15], s40 offen lds
    s_add_u32 m0, s46, 12288
    s_nop 0
    buffer_load_dwordx4 v3, s[16:19], s41 offen lds
    s_add_u32 s40, s40, 64
    s_add_u32 s41, s41, 36864
    s_add_u32 m0, s46, 16384
    s_nop 0
    buffer_load_dwordx4 v2, s[12:15], s40 offen lds
    s_add_u32 m0, s46, 20480
    s_nop 0
    buffer_load_dwordx4 v3, s[16:19], s41 offen lds
    s_add_u32 s40, s40, 64
    s_add_u32 s41, s41, 36864
    s_mov_b32 s42, 36
down_kernel_loop:
    s_waitcnt vmcnt(4)
    s_barrier
    ds_read_b128 v[16:19], v4 offset:0
    ds_read_b64_tr_b16 v[24:25], v6 offset:0
    ds_read_b64_tr_b16 v[26:27], v6 offset:512
    ds_read_b128 v[20:23], v5 offset:0
    ds_read_b64_tr_b16 v[28:29], v6 offset:2048
    ds_read_b64_tr_b16 v[30:31], v6 offset:2560
    s_add_u32 m0, s46, 24576
    s_nop 0
    buffer_load_dwordx4 v2, s[12:15], s40 offen lds
    s_add_u32 m0, s46, 28672
    s_nop 0
    buffer_load_dwordx4 v3, s[16:19], s41 offen lds
    s_add_u32 s40, s40, 64
    s_add_u32 s41, s41, 36864
    s_waitcnt lgkmcnt(3)
    v_mfma_f32_32x32x16_bf16 v[32:47], v[24:27], v[16:19], v[32:47]
    s_waitcnt lgkmcnt(0)
    v_mfma_f32_32x32x16_bf16 v[32:47], v[28:31], v[20:23], v[32:47]
    s_waitcnt vmcnt(4)
    s_barrier
    ds_read_b128 v[16:19], v4 offset:8192
    ds_read_b64_tr_b16 v[24:25], v6 offset:8192
    ds_read_b64_tr_b16 v[26:27], v6 offset:8704
    ds_read_b128 v[20:23], v5 offset:8192
    ds_read_b64_tr_b16 v[28:29], v6 offset:10240
    ds_read_b64_tr_b16 v[30:31], v6 offset:10752
    s_add_u32 m0, s46, 0
    s_nop 0
    buffer_load_dwordx4 v2, s[12:15], s40 offen lds
    s_add_u32 m0, s46, 4096
    s_nop 0
    buffer_load_dwordx4 v3, s[16:19], s41 offen lds
    s_add_u32 s40, s40, 64
    s_add_u32 s41, s41, 36864
    s_waitcnt lgkmcnt(3)
    v_mfma_f32_32x32x16_bf16 v[32:47], v[24:27], v[16:19], v[32:47]
    s_waitcnt lgkmcnt(0)
    v_mfma_f32_32x32x16_bf16 v[32:47], v[28:31], v[20:23], v[32:47]
    s_waitcnt vmcnt(4)
    s_barrier
    ds_read_b128 v[16:19], v4 offset:16384
    ds_read_b64_tr_b16 v[24:25], v6 offset:16384
    ds_read_b64_tr_b16 v[26:27], v6 offset:16896
    ds_read_b128 v[20:23], v5 offset:16384
    ds_read_b64_tr_b16 v[28:29], v6 offset:18432
    ds_read_b64_tr_b16 v[30:31], v6 offset:18944
    s_add_u32 m0, s46, 8192
    s_nop 0
    buffer_load_dwordx4 v2, s[12:15], s40 offen lds
    s_add_u32 m0, s46, 12288
    s_nop 0
    buffer_load_dwordx4 v3, s[16:19], s41 offen lds
    s_add_u32 s40, s40, 64
    s_add_u32 s41, s41, 36864
    s_waitcnt lgkmcnt(3)
    v_mfma_f32_32x32x16_bf16 v[32:47], v[24:27], v[16:19], v[32:47]
    s_waitcnt lgkmcnt(0)
    v_mfma_f32_32x32x16_bf16 v[32:47], v[28:31], v[20:23], v[32:47]
    s_waitcnt vmcnt(4)
    s_barrier
    ds_read_b128 v[16:19], v4 offset:24576
    ds_read_b64_tr_b16 v[24:25], v6 offset:24576
    ds_read_b64_tr_b16 v[26:27], v6 offset:25088
    ds_read_b128 v[20:23], v5 offset:24576
    ds_read_b64_tr_b16 v[28:29], v6 offset:26624
    ds_read_b64_tr_b16 v[30:31], v6 offset:27136
    s_add_u32 m0, s46, 16384
    s_nop 0
    buffer_load_dwordx4 v2, s[12:15], s40 offen lds
    s_add_u32 m0, s46, 20480
    s_nop 0
    buffer_load_dwordx4 v3, s[16:19], s41 offen lds
    s_add_u32 s40, s40, 64
    s_add_u32 s41, s41, 36864
    s_waitcnt lgkmcnt(3)
    v_mfma_f32_32x32x16_bf16 v[32:47], v[24:27], v[16:19], v[32:47]
    s_waitcnt lgkmcnt(0)
    v_mfma_f32_32x32x16_bf16 v[32:47], v[28:31], v[20:23], v[32:47]
    s_sub_u32 s42, s42, 1
    s_cmp_lg_u32 s42, 0
    s_cbranch_scc1 down_kernel_loop
    s_waitcnt vmcnt(0)
    s_nop 15
    v_lshrrev_b32 v48, 1, v15
    v_and_b32 v49, 1, v15
    v_and_b32 v50, 31, v1
    v_lshrrev_b32 v51, 5, v1
    v_mul_u32_u24 v52, 32, v48
    v_add3_u32 v52, v52, v50, s33
    v_mul_u32_u24 v53, 32, v49
    v_lshl_add_u32 v53, v51, 2, v53
    v_add_u32 v53, s34, v53

    s_mov_b32 s20, s8
    s_mov_b32 s21, s9
    s_mov_b32 s22, 13824
    s_mov_b32 s23, 0x00020000
    s_add_u32 s24, s8, 20971520
    s_addc_u32 s25, s9, 0
    s_mov_b32 s26, 2359296
    s_mov_b32 s27, 0x00020000
    s_mov_b32 s28, s6
    s_mov_b32 s29, s7
    s_mov_b32 s30, 2359296
    s_mov_b32 s31, 0x00020000
    v_add_u32 v54, 0, v53
    v_add_u32 v55, 0, v52
    v_mul_u32_u24 v56, 1152, v55
    v_lshl_add_u32 v56, v54, 1, v56
    v_lshlrev_b32 v57, 2, v54
    v_add_u32 v57, 11520, v57
    buffer_load_dwordx4 v[60:63], v57, s[20:23], 0 offen
    buffer_load_dwordx2 v[58:59], v56, s[24:27], 0 offen
    s_waitcnt vmcnt(0)
    v_lshlrev_b32 v64, 16, v58
    v_and_b32 v65, 0xffff0000, v58
    v_lshlrev_b32 v66, 16, v59
    v_and_b32 v67, 0xffff0000, v59
    v_fmac_f32 v64, v32, v60
    v_fmac_f32 v65, v33, v61
    v_fmac_f32 v66, v34, v62
    v_fmac_f32 v67, v35, v63
    v_cvt_pk_bf16_f32 v58, v64, v65
    v_cvt_pk_bf16_f32 v59, v66, v67
    buffer_store_dwordx2 v[58:59], v56, s[28:31], 0 offen
    v_add_u32 v54, 8, v53
    v_add_u32 v55, 0, v52
    v_mul_u32_u24 v56, 1152, v55
    v_lshl_add_u32 v56, v54, 1, v56
    v_lshlrev_b32 v57, 2, v54
    v_add_u32 v57, 11520, v57
    buffer_load_dwordx4 v[60:63], v57, s[20:23], 0 offen
    buffer_load_dwordx2 v[58:59], v56, s[24:27], 0 offen
    s_waitcnt vmcnt(0)
    v_lshlrev_b32 v64, 16, v58
    v_and_b32 v65, 0xffff0000, v58
    v_lshlrev_b32 v66, 16, v59
    v_and_b32 v67, 0xffff0000, v59
    v_fmac_f32 v64, v36, v60
    v_fmac_f32 v65, v37, v61
    v_fmac_f32 v66, v38, v62
    v_fmac_f32 v67, v39, v63
    v_cvt_pk_bf16_f32 v58, v64, v65
    v_cvt_pk_bf16_f32 v59, v66, v67
    buffer_store_dwordx2 v[58:59], v56, s[28:31], 0 offen
    v_add_u32 v54, 16, v53
    v_add_u32 v55, 0, v52
    v_mul_u32_u24 v56, 1152, v55
    v_lshl_add_u32 v56, v54, 1, v56
    v_lshlrev_b32 v57, 2, v54
    v_add_u32 v57, 11520, v57
    buffer_load_dwordx4 v[60:63], v57, s[20:23], 0 offen
    buffer_load_dwordx2 v[58:59], v56, s[24:27], 0 offen
    s_waitcnt vmcnt(0)
    v_lshlrev_b32 v64, 16, v58
    v_and_b32 v65, 0xffff0000, v58
    v_lshlrev_b32 v66, 16, v59
    v_and_b32 v67, 0xffff0000, v59
    v_fmac_f32 v64, v40, v60
    v_fmac_f32 v65, v41, v61
    v_fmac_f32 v66, v42, v62
    v_fmac_f32 v67, v43, v63
    v_cvt_pk_bf16_f32 v58, v64, v65
    v_cvt_pk_bf16_f32 v59, v66, v67
    buffer_store_dwordx2 v[58:59], v56, s[28:31], 0 offen
    v_add_u32 v54, 24, v53
    v_add_u32 v55, 0, v52
    v_mul_u32_u24 v56, 1152, v55
    v_lshl_add_u32 v56, v54, 1, v56
    v_lshlrev_b32 v57, 2, v54
    v_add_u32 v57, 11520, v57
    buffer_load_dwordx4 v[60:63], v57, s[20:23], 0 offen
    buffer_load_dwordx2 v[58:59], v56, s[24:27], 0 offen
    s_waitcnt vmcnt(0)
    v_lshlrev_b32 v64, 16, v58
    v_and_b32 v65, 0xffff0000, v58
    v_lshlrev_b32 v66, 16, v59
    v_and_b32 v67, 0xffff0000, v59
    v_fmac_f32 v64, v44, v60
    v_fmac_f32 v65, v45, v61
    v_fmac_f32 v66, v46, v62
    v_fmac_f32 v67, v47, v63
    v_cvt_pk_bf16_f32 v58, v64, v65
    v_cvt_pk_bf16_f32 v59, v66, v67
    buffer_store_dwordx2 v[58:59], v56, s[28:31], 0 offen
down_kernel_done:
    s_endpgm

.section .rodata,"a"
.p2align 6
.amdhsa_kernel mod_kernel
  .amdhsa_next_free_vgpr 100
  .amdhsa_next_free_sgpr 102
  .amdhsa_accum_offset 100
  .amdhsa_group_segment_fixed_size 0
  .amdhsa_kernarg_size 96
  .amdhsa_user_sgpr_count 2
  .amdhsa_user_sgpr_kernarg_segment_ptr 1
  .amdhsa_system_sgpr_workgroup_id_x 1
.end_amdhsa_kernel

.p2align 6
.amdhsa_kernel ln1_kernel
  .amdhsa_next_free_vgpr 96
  .amdhsa_next_free_sgpr 102
  .amdhsa_accum_offset 96
  .amdhsa_group_segment_fixed_size 0
  .amdhsa_kernarg_size 96
  .amdhsa_user_sgpr_count 2
  .amdhsa_user_sgpr_kernarg_segment_ptr 1
  .amdhsa_system_sgpr_workgroup_id_x 1
.end_amdhsa_kernel

.p2align 6
.amdhsa_kernel qkv_kernel
  .amdhsa_next_free_vgpr 136
  .amdhsa_next_free_sgpr 102
  .amdhsa_accum_offset 136
  .amdhsa_group_segment_fixed_size 0
  .amdhsa_kernarg_size 96
  .amdhsa_user_sgpr_count 2
  .amdhsa_user_sgpr_kernarg_segment_ptr 1
  .amdhsa_system_sgpr_workgroup_id_x 1
.end_amdhsa_kernel

.p2align 6
.amdhsa_kernel attn_kernel
  .amdhsa_next_free_vgpr 112
  .amdhsa_next_free_sgpr 102
  .amdhsa_accum_offset 112
  .amdhsa_group_segment_fixed_size 0
  .amdhsa_kernarg_size 96
  .amdhsa_user_sgpr_count 2
  .amdhsa_user_sgpr_kernarg_segment_ptr 1
  .amdhsa_system_sgpr_workgroup_id_x 1
.end_amdhsa_kernel

.p2align 6
.amdhsa_kernel wo_kernel
  .amdhsa_next_free_vgpr 72
  .amdhsa_next_free_sgpr 102
  .amdhsa_accum_offset 72
  .amdhsa_group_segment_fixed_size 0
  .amdhsa_kernarg_size 96
  .amdhsa_user_sgpr_count 2
  .amdhsa_user_sgpr_kernarg_segment_ptr 1
  .amdhsa_system_sgpr_workgroup_id_x 1
.end_amdhsa_kernel

.p2align 6
.amdhsa_kernel ln2_kernel
  .amdhsa_next_free_vgpr 96
  .amdhsa_next_free_sgpr 102
  .amdhsa_accum_offset 96
  .amdhsa_group_segment_fixed_size 0
  .amdhsa_kernarg_size 96
  .amdhsa_user_sgpr_count 2
  .amdhsa_user_sgpr_kernarg_segment_ptr 1
  .amdhsa_system_sgpr_workgroup_id_x 1
.end_amdhsa_kernel

.p2align 6
.amdhsa_kernel gu_kernel
  .amdhsa_next_free_vgpr 240
  .amdhsa_next_free_sgpr 102
  .amdhsa_accum_offset 240
  .amdhsa_group_segment_fixed_size 0
  .amdhsa_kernarg_size 96
  .amdhsa_user_sgpr_count 2
  .amdhsa_user_sgpr_kernarg_segment_ptr 1
  .amdhsa_system_sgpr_workgroup_id_x 1
.end_amdhsa_kernel

.p2align 6
.amdhsa_kernel down_kernel
  .amdhsa_next_free_vgpr 72
  .amdhsa_next_free_sgpr 102
  .amdhsa_accum_offset 72
  .amdhsa_group_segment_fixed_size 0
  .amdhsa_kernarg_size 96
  .amdhsa_user_sgpr_count 2
  .amdhsa_user_sgpr_kernarg_segment_ptr 1
  .amdhsa_system_sgpr_workgroup_id_x 1
.end_amdhsa_kernel
```
